```python
import torch

def _softmax(x, axis=-1):
    return torch.softmax(x, dim=axis)
def _gelu(x):
    return torch.nn.functional.gelu(x, approximate="tanh")
def _silu(x):
    return torch.nn.functional.silu(x)
def _sigmoid(x):
    return torch.sigmoid(x)
def _layernorm(x, axis=-1, eps=1e-5):
    m = x.mean(dim=axis, keepdim=True)
    v = x.var(dim=axis, keepdim=True, unbiased=False)
    return (x - m) / torch.sqrt(v + eps)
def _scatter_add(tgt, idx, src, axis=0):
    return tgt.clone().index_add_(axis, idx, src)
def _segment_sum(src, seg, n):
    out = torch.zeros((n,) + src.shape[1:], dtype=src.dtype)
    return out.index_add_(0, seg, src)
def _pad(x, pw):
    flat = tuple(v for pair in reversed(pw) for v in pair)
    return torch.nn.functional.pad(x, flat)

kernel_name = 'concat_heads__mha_block_cached__mha_block_cached__near_ridge'

def setup_inputs():

    _w = (lambda a: (lambda t: t.to(torch.bfloat16) if t.is_floating_point() else t)(torch.as_tensor(a)))
    def _A_setup():
        B, Sq, D = 16, 32, 1024
        H, Sk, Dh = 32, 32, 128
        return {
            "x": _w((lambda *s: torch.randn(*s, dtype=torch.bfloat16) * 0.8)(B, Sq, D)),
            "k_cache": _w((lambda *s: torch.randn(*s, dtype=torch.bfloat16) * 0.8)(B, H, Sk, Dh)),
            "v_cache": _w((lambda *s: torch.randn(*s, dtype=torch.bfloat16) * 0.05)(B, H, Sk, Dh)),
            "wq": _w((lambda *s: torch.randn(*s, dtype=torch.bfloat16) * 0.8)(D, H * Dh) * (D ** -0.5)),
            "wo": _w((lambda *s: torch.randn(*s, dtype=torch.bfloat16) * 0.05)(H * Dh, D) * ((H * Dh) ** -0.5)),
        }
    _A_in = _A_setup()

    def _B_setup():
        B, Sq, D = 16, 32, 1024
        H, Sk, Dh = 32, 32, 128
        return {
            "x": _w((lambda *s: torch.randn(*s, dtype=torch.bfloat16) * 0.8)(B, Sq, D)),
            "k_cache": _w((lambda *s: torch.randn(*s, dtype=torch.bfloat16) * 0.8)(B, H, Sk, Dh)),
            "v_cache": _w((lambda *s: torch.randn(*s, dtype=torch.bfloat16) * 0.05)(B, H, Sk, Dh)),
            "wq": _w((lambda *s: torch.randn(*s, dtype=torch.bfloat16) * 0.8)(D, H * Dh) * (D ** -0.5)),
            "wo": _w((lambda *s: torch.randn(*s, dtype=torch.bfloat16) * 0.05)(H * Dh, D) * ((H * Dh) ** -0.5)),
        }
    _B_in = _B_setup()

    return {
        "A_x": _A_in["x"],
        "A_k_cache": _A_in["k_cache"],
        "A_v_cache": _A_in["v_cache"],
        "A_wq": _A_in["wq"],
        "A_wo": _A_in["wo"],
        "B_x": _B_in["x"],
        "B_k_cache": _B_in["k_cache"],
        "B_v_cache": _B_in["v_cache"],
        "B_wq": _B_in["wq"],
        "B_wo": _B_in["wo"],
    }

def reference(A_x, A_k_cache, A_v_cache, A_wq, A_wo, B_x, B_k_cache, B_v_cache, B_wq, B_wo):
    def _A_ref(x, k_cache, v_cache, wq, wo):
        B, Sq, D = x.shape
        H, Dh = 32, 128
        q = (lambda x, *d: x.permute(*d))((x @ wq).reshape(B, Sq, H, Dh), 0, 2, 1, 3)
        scores = torch.einsum("bhqd,bhkd->bhqk", q, k_cache) * (Dh ** -0.5)
        p = _softmax(scores, axis=-1)
        o = torch.einsum("bhqk,bhkd->bhqd", p, v_cache)
        return (lambda x, *d: x.permute(*d))(o, 0, 2, 1, 3).reshape(B, Sq, H * Dh) @ wo

    def _B_ref(x, k_cache, v_cache, wq, wo):
        B, Sq, D = x.shape
        H, Dh = 32, 128
        q = (lambda x, *d: x.permute(*d))((x @ wq).reshape(B, Sq, H, Dh), 0, 2, 1, 3)
        scores = torch.einsum("bhqd,bhkd->bhqk", q, k_cache) * (Dh ** -0.5)
        p = _softmax(scores, axis=-1)
        o = torch.einsum("bhqk,bhkd->bhqd", p, v_cache)
        return (lambda x, *d: x.permute(*d))(o, 0, 2, 1, 3).reshape(B, Sq, H * Dh) @ wo

    a = _A_ref(A_x, A_k_cache, A_v_cache, A_wq, A_wo)
    b = _B_ref(B_x, B_k_cache, B_v_cache, B_wq, B_wo)
    return torch.concatenate([a, b], axis=-1)
```

```asm
; @launch grid=(256,1,1) block=(512,1,1) lds=163840
.amdgcn_target "amdgcn-amd-amdhsa--gfx950"
.text
.globl concat_heads__mha_block_cached__mha_block_cached__near_ridge_kernel
.p2align 8
.type concat_heads__mha_block_cached__mha_block_cached__near_ridge_kernel,@function
concat_heads__mha_block_cached__mha_block_cached__near_ridge_kernel:
    s_bfe_u32 s3, s2, 0x10002
    s_mul_i32 s41, s3, 40
    s_add_u32 s42, s0, s41
    s_addc_u32 s43, s1, 0
    s_cmp_ge_u32 s2, 256
    s_cbranch_scc1 L_end
    s_load_dwordx2 s[20:21], s[42:43], 24
    s_load_dwordx2 s[8:9], s[42:43], 0
    v_lshrrev_b32 v1, 6, v0
    v_and_b32 v0, 63, v0
    s_load_dwordx2 s[28:29], s[0:1], 96
    v_readfirstlane_b32 s7, v1
    s_and_b32 s4, s2, 3
    s_lshr_b32 s5, s2, 6
    s_bfe_u32 s6, s2, 0x30003
    s_lshl_b32 s39, s5, 1
    s_add_u32 s39, s39, s6
    s_and_b32 s39, s39, 7
    s_sub_u32 s40, s7, 4
    s_cmp_ge_u32 s40, 2
    s_cbranch_scc1 L_other
    s_mov_b32 s22, 0x800000
    s_mov_b32 s23, 0x20000
    s_mov_b32 s10, 0x100000
    s_mov_b32 s11, 0x20000
    v_lshrrev_b32 v3, 4, v0
    v_and_b32 v2, 15, v0
    v_lshlrev_b32 v4, 2, v3
    v_xor_b32 v2, v2, v4
    v_lshlrev_b32 v2, 4, v2
    v_xor_b32 v5, 32, v2
    s_lshl_b32 s41, s40, 2
    v_add_u32 v6, s41, v3
    v_lshl_add_u32 v12, v6, 13, v2
    v_lshl_add_u32 v13, v6, 13, v5
    s_lshl_b32 s45, s40, 10
    s_lshl_b32 s50, s5, 2
    s_xor_b32 s51, s39, 1
    s_lshl_b32 s51, s51, 1
    s_add_u32 s50, s50, s51
    s_lshl_b32 s51, s4, 3
    s_add_u32 s51, s51, s39
    s_lshl_b32 s53, s51, 8
    s_and_b32 s54, s50, 15
    s_lshl_b32 s55, s54, 19
    s_add_u32 s48, s53, s55
    s_lshl_b32 s52, s5, 18
    s_lshl_b32 s55, s54, 7
    s_add_u32 s47, s52, s55
    v_lshrrev_b32 v1, 3, v0
    v_and_b32 v7, 7, v0
    v_xor_b32 v7, v7, v6
    v_lshlrev_b32 v7, 4, v7
    s_lshl_b32 s41, s40, 3
    v_add_u32 v1, s41, v1
    v_lshl_add_u32 v10, v1, 11, v7
    s_waitcnt lgkmcnt(0)
    s_add_u32 m0, s45, 16384
    s_add_u32 s41, s48, 0x0
    buffer_load_dwordx4 v12, s[20:23], s41 offen  lds
    s_add_u32 m0, s45, 18432
    s_add_u32 s41, s48, 0x10000
    buffer_load_dwordx4 v13, s[20:23], s41 offen  lds
    s_add_u32 m0, s45, 20480
    s_add_u32 s41, s48, 0x20000
    buffer_load_dwordx4 v12, s[20:23], s41 offen  lds
    s_add_u32 m0, s45, 22528
    s_add_u32 s41, s48, 0x30000
    buffer_load_dwordx4 v13, s[20:23], s41 offen  lds
    s_add_u32 m0, s45, 24576
    s_add_u32 s41, s48, 0x40000
    buffer_load_dwordx4 v12, s[20:23], s41 offen  lds
    s_add_u32 m0, s45, 26624
    s_add_u32 s41, s48, 0x50000
    buffer_load_dwordx4 v13, s[20:23], s41 offen  lds
    s_add_u32 m0, s45, 28672
    s_add_u32 s41, s48, 0x60000
    buffer_load_dwordx4 v12, s[20:23], s41 offen  lds
    s_add_u32 m0, s45, 30720
    s_add_u32 s41, s48, 0x70000
    buffer_load_dwordx4 v13, s[20:23], s41 offen  lds
    s_add_u32 m0, s45, 0
    s_add_u32 s41, s47, 0x0
    buffer_load_dwordx4 v10, s[8:11], s41 offen  lds
    s_add_u32 m0, s45, 2048
    s_add_u32 s41, s47, 0x8000
    buffer_load_dwordx4 v10, s[8:11], s41 offen  lds
    s_add_u32 m0, s45, 4096
    s_add_u32 s41, s47, 0x10000
    buffer_load_dwordx4 v10, s[8:11], s41 offen  lds
    s_add_u32 m0, s45, 6144
    s_add_u32 s41, s47, 0x18000
    buffer_load_dwordx4 v10, s[8:11], s41 offen  lds
    s_add_u32 m0, s45, 8192
    s_add_u32 s41, s47, 0x20000
    buffer_load_dwordx4 v10, s[8:11], s41 offen  lds
    s_add_u32 m0, s45, 10240
    s_add_u32 s41, s47, 0x28000
    buffer_load_dwordx4 v10, s[8:11], s41 offen  lds
    s_add_u32 m0, s45, 12288
    s_add_u32 s41, s47, 0x30000
    buffer_load_dwordx4 v10, s[8:11], s41 offen  lds
    s_add_u32 m0, s45, 14336
    s_add_u32 s41, s47, 0x38000
    buffer_load_dwordx4 v10, s[8:11], s41 offen  lds
    s_load_dwordx2 s[12:13], s[42:43], 8
    s_load_dwordx2 s[16:17], s[42:43], 16
    s_load_dwordx2 s[24:25], s[42:43], 32
    s_mov_b32 s14, 0x400000
    s_mov_b32 s15, 0x20000
    s_mov_b32 s18, 0x400000
    s_mov_b32 s19, 0x20000
    s_mov_b32 s26, 0x800000
    s_mov_b32 s27, 0x20000
    s_mov_b32 s30, 0x1400000
    s_mov_b32 s31, 0x20000
    s_lshl_b32 s38, s3, 2
    s_add_u32 s38, s38, s5
    s_lshl_b32 s61, s38, 2
    s_add_u32 s61, s61, s4
    v_lshl_add_u32 v11, v1, 8, v7
    v_lshl_add_u32 v14, v6, 11, v2
    v_lshl_add_u32 v15, v6, 11, v5
    s_xor_b32 s44, s6, 3
    s_sub_u32 s44, s44, s6
    s_lshl_b32 s44, s44, 8
    v_bfe_u32 v6, v2, 7, 1
    v_mul_lo_u32 v6, v6, s44
    s_lshl_b32 s44, s6, 8
    v_add_u32 v6, s44, v6
    v_add_u32 v14, v14, v6
    v_add_u32 v15, v15, v6
    v_lshlrev_b32 v16, 4, v0
    v_add_u32 v16, s45, v16
    s_lshl_b32 s56, s5, 20
    s_lshl_b32 s41, s51, 13
    s_add_u32 s57, s56, s41
    s_lshl_b32 s41, s4, 16
    s_add_u32 s58, s56, s41
    s_lshl_b32 s59, s4, 21
    s_lshl_b32 s49, s61, 16
    s_add_u32 s49, s49, 0x100000
    s_mov_b32 s46, 0x75364120
    s_and_b32 s41, s6, 3
    s_cmp_eq_u32 s41, 1
    s_cselect_b32 s46, 0x75361420, s46
    s_and_b32 s41, s6, 3
    s_cmp_eq_u32 s41, 2
    s_cselect_b32 s46, 0x75316420, s46
    s_and_b32 s41, s6, 3
    s_cmp_eq_u32 s41, 3
    s_cselect_b32 s46, 0x75361420, s46
    s_mul_i32 s41, s39, 0x11111111
    s_add_u32 s46, s46, s41
    s_and_b32 s46, s46, 0x77777777
    s_waitcnt lgkmcnt(0)
    s_mov_b32 s42, 0xa162c840
    s_mov_b32 s43, 0xfb73d95e
    s_and_b32 s41, s2, 1
    s_cmp_eq_u32 s41, 1
    s_cselect_b32 s42, 0xea62c840, s42
    s_cselect_b32 s43, 0xfb73d951, s43
    s_bfe_u32 s54, s42, 0x40004
    s_add_u32 s54, s54, s50
    s_and_b32 s54, s54, 15
    s_lshl_b32 s55, s54, 7
    s_add_u32 s47, s52, s55
    s_lshl_b32 s55, s54, 19
    s_add_u32 s48, s53, s55
    s_add_u32 m0, s45, 49152
    s_add_u32 s41, s48, 0x0
    buffer_load_dwordx4 v12, s[20:23], s41 offen  lds
    s_add_u32 m0, s45, 51200
    s_add_u32 s41, s48, 0x10000
    buffer_load_dwordx4 v13, s[20:23], s41 offen  lds
    s_add_u32 m0, s45, 53248
    s_add_u32 s41, s48, 0x20000
    buffer_load_dwordx4 v12, s[20:23], s41 offen  lds
    s_add_u32 m0, s45, 55296
    s_add_u32 s41, s48, 0x30000
    buffer_load_dwordx4 v13, s[20:23], s41 offen  lds
    s_add_u32 m0, s45, 57344
    s_add_u32 s41, s48, 0x40000
    buffer_load_dwordx4 v12, s[20:23], s41 offen  lds
    s_add_u32 m0, s45, 59392
    s_add_u32 s41, s48, 0x50000
    buffer_load_dwordx4 v13, s[20:23], s41 offen  lds
    s_add_u32 m0, s45, 61440
    s_add_u32 s41, s48, 0x60000
    buffer_load_dwordx4 v12, s[20:23], s41 offen  lds
    s_add_u32 m0, s45, 63488
    s_add_u32 s41, s48, 0x70000
    buffer_load_dwordx4 v13, s[20:23], s41 offen  lds
    s_add_u32 m0, s45, 32768
    s_add_u32 s41, s47, 0x0
    buffer_load_dwordx4 v10, s[8:11], s41 offen  lds
    s_add_u32 m0, s45, 34816
    s_add_u32 s41, s47, 0x8000
    buffer_load_dwordx4 v10, s[8:11], s41 offen  lds
    s_add_u32 m0, s45, 36864
    s_add_u32 s41, s47, 0x10000
    buffer_load_dwordx4 v10, s[8:11], s41 offen  lds
    s_add_u32 m0, s45, 38912
    s_add_u32 s41, s47, 0x18000
    buffer_load_dwordx4 v10, s[8:11], s41 offen  lds
    s_add_u32 m0, s45, 40960
    s_add_u32 s41, s47, 0x20000
    buffer_load_dwordx4 v10, s[8:11], s41 offen  lds
    s_add_u32 m0, s45, 43008
    s_add_u32 s41, s47, 0x28000
    buffer_load_dwordx4 v10, s[8:11], s41 offen  lds
    s_add_u32 m0, s45, 45056
    s_add_u32 s41, s47, 0x30000
    buffer_load_dwordx4 v10, s[8:11], s41 offen  lds
    s_add_u32 m0, s45, 47104
    s_add_u32 s41, s47, 0x38000
    buffer_load_dwordx4 v10, s[8:11], s41 offen  lds
    s_bfe_u32 s54, s42, 0x40008
    s_add_u32 s54, s54, s50
    s_and_b32 s54, s54, 15
    s_lshl_b32 s55, s54, 7
    s_add_u32 s47, s52, s55
    s_lshl_b32 s55, s54, 19
    s_add_u32 s48, s53, s55
    s_add_u32 m0, s45, 81920
    s_add_u32 s41, s48, 0x0
    buffer_load_dwordx4 v12, s[20:23], s41 offen  lds
    s_add_u32 m0, s45, 83968
    s_add_u32 s41, s48, 0x10000
    buffer_load_dwordx4 v13, s[20:23], s41 offen  lds
    s_waitcnt vmcnt(18)
    s_barrier
    s_add_u32 m0, s45, 86016
    s_add_u32 s41, s48, 0x20000
    buffer_load_dwordx4 v12, s[20:23], s41 offen  lds
    s_add_u32 m0, s45, 88064
    s_add_u32 s41, s48, 0x30000
    buffer_load_dwordx4 v13, s[20:23], s41 offen  lds
    s_add_u32 m0, s45, 90112
    s_add_u32 s41, s48, 0x40000
    buffer_load_dwordx4 v12, s[20:23], s41 offen  lds
    s_add_u32 m0, s45, 92160
    s_add_u32 s41, s48, 0x50000
    buffer_load_dwordx4 v13, s[20:23], s41 offen  lds
    s_add_u32 m0, s45, 94208
    s_add_u32 s41, s48, 0x60000
    buffer_load_dwordx4 v12, s[20:23], s41 offen  lds
    s_add_u32 m0, s45, 96256
    s_add_u32 s41, s48, 0x70000
    buffer_load_dwordx4 v13, s[20:23], s41 offen  lds
    s_add_u32 m0, s45, 65536
    s_add_u32 s41, s47, 0x0
    buffer_load_dwordx4 v10, s[8:11], s41 offen  lds
    s_add_u32 m0, s45, 67584
    s_add_u32 s41, s47, 0x8000
    buffer_load_dwordx4 v10, s[8:11], s41 offen  lds
    s_add_u32 m0, s45, 69632
    s_add_u32 s41, s47, 0x10000
    buffer_load_dwordx4 v10, s[8:11], s41 offen  lds
    s_add_u32 m0, s45, 71680
    s_add_u32 s41, s47, 0x18000
    buffer_load_dwordx4 v10, s[8:11], s41 offen  lds
    s_add_u32 m0, s45, 73728
    s_add_u32 s41, s47, 0x20000
    buffer_load_dwordx4 v10, s[8:11], s41 offen  lds
    s_add_u32 m0, s45, 75776
    s_add_u32 s41, s47, 0x28000
    buffer_load_dwordx4 v10, s[8:11], s41 offen  lds
    s_add_u32 m0, s45, 77824
    s_add_u32 s41, s47, 0x30000
    buffer_load_dwordx4 v10, s[8:11], s41 offen  lds
    s_add_u32 m0, s45, 79872
    s_add_u32 s41, s47, 0x38000
    buffer_load_dwordx4 v10, s[8:11], s41 offen  lds
    s_bfe_u32 s54, s42, 0x4000c
    s_add_u32 s54, s54, s50
    s_and_b32 s54, s54, 15
    s_lshl_b32 s55, s54, 7
    s_add_u32 s47, s52, s55
    s_lshl_b32 s55, s54, 19
    s_add_u32 s48, s53, s55
    s_add_u32 m0, s45, 114688
    s_add_u32 s41, s48, 0x0
    buffer_load_dwordx4 v12, s[20:23], s41 offen  lds
    s_add_u32 m0, s45, 116736
    s_add_u32 s41, s48, 0x10000
    buffer_load_dwordx4 v13, s[20:23], s41 offen  lds
    s_waitcnt vmcnt(18)
    s_barrier
    s_add_u32 m0, s45, 118784
    s_add_u32 s41, s48, 0x20000
    buffer_load_dwordx4 v12, s[20:23], s41 offen  lds
    s_add_u32 m0, s45, 120832
    s_add_u32 s41, s48, 0x30000
    buffer_load_dwordx4 v13, s[20:23], s41 offen  lds
    s_add_u32 m0, s45, 122880
    s_add_u32 s41, s48, 0x40000
    buffer_load_dwordx4 v12, s[20:23], s41 offen  lds
    s_add_u32 m0, s45, 124928
    s_add_u32 s41, s48, 0x50000
    buffer_load_dwordx4 v13, s[20:23], s41 offen  lds
    s_add_u32 m0, s45, 126976
    s_add_u32 s41, s48, 0x60000
    buffer_load_dwordx4 v12, s[20:23], s41 offen  lds
    s_add_u32 m0, s45, 129024
    s_add_u32 s41, s48, 0x70000
    buffer_load_dwordx4 v13, s[20:23], s41 offen  lds
    s_add_u32 m0, s45, 98304
    s_add_u32 s41, s47, 0x0
    buffer_load_dwordx4 v10, s[8:11], s41 offen  lds
    s_add_u32 m0, s45, 100352
    s_add_u32 s41, s47, 0x8000
    buffer_load_dwordx4 v10, s[8:11], s41 offen  lds
    s_add_u32 m0, s45, 102400
    s_add_u32 s41, s47, 0x10000
    buffer_load_dwordx4 v10, s[8:11], s41 offen  lds
    s_add_u32 m0, s45, 104448
    s_add_u32 s41, s47, 0x18000
    buffer_load_dwordx4 v10, s[8:11], s41 offen  lds
    s_add_u32 m0, s45, 106496
    s_add_u32 s41, s47, 0x20000
    buffer_load_dwordx4 v10, s[8:11], s41 offen  lds
    s_add_u32 m0, s45, 108544
    s_add_u32 s41, s47, 0x28000
    buffer_load_dwordx4 v10, s[8:11], s41 offen  lds
    s_add_u32 m0, s45, 110592
    s_add_u32 s41, s47, 0x30000
    buffer_load_dwordx4 v10, s[8:11], s41 offen  lds
    s_add_u32 m0, s45, 112640
    s_add_u32 s41, s47, 0x38000
    buffer_load_dwordx4 v10, s[8:11], s41 offen  lds
    s_bfe_u32 s54, s42, 0x40010
    s_add_u32 s54, s54, s50
    s_and_b32 s54, s54, 15
    s_lshl_b32 s55, s54, 7
    s_add_u32 s47, s52, s55
    s_lshl_b32 s55, s54, 19
    s_add_u32 s48, s53, s55
    s_add_u32 m0, s45, 16384
    s_add_u32 s41, s48, 0x0
    buffer_load_dwordx4 v12, s[20:23], s41 offen  lds
    s_add_u32 m0, s45, 18432
    s_add_u32 s41, s48, 0x10000
    buffer_load_dwordx4 v13, s[20:23], s41 offen  lds
    s_add_u32 m0, s45, 20480
    s_add_u32 s41, s48, 0x20000
    buffer_load_dwordx4 v12, s[20:23], s41 offen  lds
    s_add_u32 m0, s45, 22528
    s_add_u32 s41, s48, 0x30000
    buffer_load_dwordx4 v13, s[20:23], s41 offen  lds
    s_waitcnt vmcnt(20)
    s_barrier
    s_add_u32 m0, s45, 24576
    s_add_u32 s41, s48, 0x40000
    buffer_load_dwordx4 v12, s[20:23], s41 offen  lds
    s_add_u32 m0, s45, 26624
    s_add_u32 s41, s48, 0x50000
    buffer_load_dwordx4 v13, s[20:23], s41 offen  lds
    s_add_u32 m0, s45, 28672
    s_add_u32 s41, s48, 0x60000
    buffer_load_dwordx4 v12, s[20:23], s41 offen  lds
    s_add_u32 m0, s45, 30720
    s_add_u32 s41, s48, 0x70000
    buffer_load_dwordx4 v13, s[20:23], s41 offen  lds
    s_add_u32 m0, s45, 131072
    s_add_u32 s41, s57, 0x0
    buffer_load_dwordx4 v11, s[12:15], s41 offen  lds
    s_add_u32 m0, s45, 147456
    s_add_u32 s41, s57, 0x80
    buffer_load_dwordx4 v11, s[12:15], s41 offen  lds
    s_add_u32 m0, s45, 133120
    s_add_u32 s41, s57, 0x1000
    buffer_load_dwordx4 v11, s[12:15], s41 offen  lds
    s_add_u32 m0, s45, 149504
    s_add_u32 s41, s57, 0x1080
    buffer_load_dwordx4 v11, s[12:15], s41 offen  lds
    s_add_u32 m0, s45, 135168
    s_add_u32 s41, s57, 0x40000
    buffer_load_dwordx4 v11, s[12:15], s41 offen  lds
    s_add_u32 m0, s45, 151552
    s_add_u32 s41, s57, 0x40080
    buffer_load_dwordx4 v11, s[12:15], s41 offen  lds
    s_add_u32 m0, s45, 137216
    s_add_u32 s41, s57, 0x41000
    buffer_load_dwordx4 v11, s[12:15], s41 offen  lds
    s_add_u32 m0, s45, 153600
    s_add_u32 s41, s57, 0x41080
    buffer_load_dwordx4 v11, s[12:15], s41 offen  lds
    s_add_u32 m0, s45, 0
    s_add_u32 s41, s47, 0x0
    buffer_load_dwordx4 v10, s[8:11], s41 offen  lds
    s_add_u32 m0, s45, 2048
    s_add_u32 s41, s47, 0x8000
    buffer_load_dwordx4 v10, s[8:11], s41 offen  lds
    s_add_u32 m0, s45, 4096
    s_add_u32 s41, s47, 0x10000
    buffer_load_dwordx4 v10, s[8:11], s41 offen  lds
    s_add_u32 m0, s45, 6144
    s_add_u32 s41, s47, 0x18000
    buffer_load_dwordx4 v10, s[8:11], s41 offen  lds
    s_add_u32 m0, s45, 8192
    s_add_u32 s41, s47, 0x20000
    buffer_load_dwordx4 v10, s[8:11], s41 offen  lds
    s_add_u32 m0, s45, 10240
    s_add_u32 s41, s47, 0x28000
    buffer_load_dwordx4 v10, s[8:11], s41 offen  lds
    s_add_u32 m0, s45, 12288
    s_add_u32 s41, s47, 0x30000
    buffer_load_dwordx4 v10, s[8:11], s41 offen  lds
    s_add_u32 m0, s45, 14336
    s_add_u32 s41, s47, 0x38000
    buffer_load_dwordx4 v10, s[8:11], s41 offen  lds
    s_bfe_u32 s54, s42, 0x40014
    s_add_u32 s54, s54, s50
    s_and_b32 s54, s54, 15
    s_lshl_b32 s55, s54, 7
    s_add_u32 s47, s52, s55
    s_lshl_b32 s55, s54, 19
    s_add_u32 s48, s53, s55
    s_add_u32 m0, s45, 49152
    s_add_u32 s41, s48, 0x0
    buffer_load_dwordx4 v12, s[20:23], s41 offen  lds
    s_add_u32 m0, s45, 51200
    s_add_u32 s41, s48, 0x10000
    buffer_load_dwordx4 v13, s[20:23], s41 offen  lds
    s_add_u32 m0, s45, 53248
    s_add_u32 s41, s48, 0x20000
    buffer_load_dwordx4 v12, s[20:23], s41 offen  lds
    s_add_u32 m0, s45, 55296
    s_add_u32 s41, s48, 0x30000
    buffer_load_dwordx4 v13, s[20:23], s41 offen  lds
    s_waitcnt vmcnt(28)
    s_barrier
    s_add_u32 m0, s45, 57344
    s_add_u32 s41, s48, 0x40000
    buffer_load_dwordx4 v12, s[20:23], s41 offen  lds
    s_add_u32 m0, s45, 59392
    s_add_u32 s41, s48, 0x50000
    buffer_load_dwordx4 v13, s[20:23], s41 offen  lds
    s_add_u32 m0, s45, 61440
    s_add_u32 s41, s48, 0x60000
    buffer_load_dwordx4 v12, s[20:23], s41 offen  lds
    s_add_u32 m0, s45, 63488
    s_add_u32 s41, s48, 0x70000
    buffer_load_dwordx4 v13, s[20:23], s41 offen  lds
    s_add_u32 m0, s45, 32768
    s_add_u32 s41, s47, 0x0
    buffer_load_dwordx4 v10, s[8:11], s41 offen  lds
    s_add_u32 m0, s45, 34816
    s_add_u32 s41, s47, 0x8000
    buffer_load_dwordx4 v10, s[8:11], s41 offen  lds
    s_add_u32 m0, s45, 36864
    s_add_u32 s41, s47, 0x10000
    buffer_load_dwordx4 v10, s[8:11], s41 offen  lds
    s_add_u32 m0, s45, 38912
    s_add_u32 s41, s47, 0x18000
    buffer_load_dwordx4 v10, s[8:11], s41 offen  lds
    s_add_u32 m0, s45, 40960
    s_add_u32 s41, s47, 0x20000
    buffer_load_dwordx4 v10, s[8:11], s41 offen  lds
    s_add_u32 m0, s45, 43008
    s_add_u32 s41, s47, 0x28000
    buffer_load_dwordx4 v10, s[8:11], s41 offen  lds
    s_add_u32 m0, s45, 45056
    s_add_u32 s41, s47, 0x30000
    buffer_load_dwordx4 v10, s[8:11], s41 offen  lds
    s_add_u32 m0, s45, 47104
    s_add_u32 s41, s47, 0x38000
    buffer_load_dwordx4 v10, s[8:11], s41 offen  lds
    s_bfe_u32 s54, s42, 0x40018
    s_add_u32 s54, s54, s50
    s_and_b32 s54, s54, 15
    s_lshl_b32 s55, s54, 7
    s_add_u32 s47, s52, s55
    s_lshl_b32 s55, s54, 19
    s_add_u32 s48, s53, s55
    s_add_u32 m0, s45, 81920
    s_add_u32 s41, s48, 0x0
    buffer_load_dwordx4 v12, s[20:23], s41 offen  lds
    s_add_u32 m0, s45, 83968
    s_add_u32 s41, s48, 0x10000
    buffer_load_dwordx4 v13, s[20:23], s41 offen  lds
    s_add_u32 m0, s45, 86016
    s_add_u32 s41, s48, 0x20000
    buffer_load_dwordx4 v12, s[20:23], s41 offen  lds
    s_add_u32 m0, s45, 88064
    s_add_u32 s41, s48, 0x30000
    buffer_load_dwordx4 v13, s[20:23], s41 offen  lds
    s_waitcnt vmcnt(20)
    s_barrier
    s_add_u32 m0, s45, 90112
    s_add_u32 s41, s48, 0x40000
    buffer_load_dwordx4 v12, s[20:23], s41 offen  lds
    s_add_u32 m0, s45, 92160
    s_add_u32 s41, s48, 0x50000
    buffer_load_dwordx4 v13, s[20:23], s41 offen  lds
    s_add_u32 m0, s45, 94208
    s_add_u32 s41, s48, 0x60000
    buffer_load_dwordx4 v12, s[20:23], s41 offen  lds
    s_add_u32 m0, s45, 96256
    s_add_u32 s41, s48, 0x70000
    buffer_load_dwordx4 v13, s[20:23], s41 offen  lds
    s_add_u32 m0, s45, 65536
    s_add_u32 s41, s47, 0x0
    buffer_load_dwordx4 v10, s[8:11], s41 offen  lds
    s_add_u32 m0, s45, 67584
    s_add_u32 s41, s47, 0x8000
    buffer_load_dwordx4 v10, s[8:11], s41 offen  lds
    s_add_u32 m0, s45, 69632
    s_add_u32 s41, s47, 0x10000
    buffer_load_dwordx4 v10, s[8:11], s41 offen  lds
    s_add_u32 m0, s45, 71680
    s_add_u32 s41, s47, 0x18000
    buffer_load_dwordx4 v10, s[8:11], s41 offen  lds
    s_add_u32 m0, s45, 73728
    s_add_u32 s41, s47, 0x20000
    buffer_load_dwordx4 v10, s[8:11], s41 offen  lds
    s_add_u32 m0, s45, 75776
    s_add_u32 s41, s47, 0x28000
    buffer_load_dwordx4 v10, s[8:11], s41 offen  lds
    s_add_u32 m0, s45, 77824
    s_add_u32 s41, s47, 0x30000
    buffer_load_dwordx4 v10, s[8:11], s41 offen  lds
    s_add_u32 m0, s45, 79872
    s_add_u32 s41, s47, 0x38000
    buffer_load_dwordx4 v10, s[8:11], s41 offen  lds
    s_bfe_u32 s54, s42, 0x4001c
    s_add_u32 s54, s54, s50
    s_and_b32 s54, s54, 15
    s_lshl_b32 s55, s54, 7
    s_add_u32 s47, s52, s55
    s_lshl_b32 s55, s54, 19
    s_add_u32 s48, s53, s55
    s_add_u32 m0, s45, 114688
    s_add_u32 s41, s48, 0x0
    buffer_load_dwordx4 v12, s[20:23], s41 offen  lds
    s_add_u32 m0, s45, 116736
    s_add_u32 s41, s48, 0x10000
    buffer_load_dwordx4 v13, s[20:23], s41 offen  lds
    s_add_u32 m0, s45, 118784
    s_add_u32 s41, s48, 0x20000
    buffer_load_dwordx4 v12, s[20:23], s41 offen  lds
    s_add_u32 m0, s45, 120832
    s_add_u32 s41, s48, 0x30000
    buffer_load_dwordx4 v13, s[20:23], s41 offen  lds
    s_waitcnt vmcnt(20)
    s_barrier
    s_add_u32 m0, s45, 122880
    s_add_u32 s41, s48, 0x40000
    buffer_load_dwordx4 v12, s[20:23], s41 offen  lds
    s_add_u32 m0, s45, 124928
    s_add_u32 s41, s48, 0x50000
    buffer_load_dwordx4 v13, s[20:23], s41 offen  lds
    s_add_u32 m0, s45, 126976
    s_add_u32 s41, s48, 0x60000
    buffer_load_dwordx4 v12, s[20:23], s41 offen  lds
    s_add_u32 m0, s45, 129024
    s_add_u32 s41, s48, 0x70000
    buffer_load_dwordx4 v13, s[20:23], s41 offen  lds
    s_add_u32 m0, s45, 98304
    s_add_u32 s41, s47, 0x0
    buffer_load_dwordx4 v10, s[8:11], s41 offen  lds
    s_add_u32 m0, s45, 100352
    s_add_u32 s41, s47, 0x8000
    buffer_load_dwordx4 v10, s[8:11], s41 offen  lds
    s_add_u32 m0, s45, 102400
    s_add_u32 s41, s47, 0x10000
    buffer_load_dwordx4 v10, s[8:11], s41 offen  lds
    s_add_u32 m0, s45, 104448
    s_add_u32 s41, s47, 0x18000
    buffer_load_dwordx4 v10, s[8:11], s41 offen  lds
    s_add_u32 m0, s45, 106496
    s_add_u32 s41, s47, 0x20000
    buffer_load_dwordx4 v10, s[8:11], s41 offen  lds
    s_add_u32 m0, s45, 108544
    s_add_u32 s41, s47, 0x28000
    buffer_load_dwordx4 v10, s[8:11], s41 offen  lds
    s_add_u32 m0, s45, 110592
    s_add_u32 s41, s47, 0x30000
    buffer_load_dwordx4 v10, s[8:11], s41 offen  lds
    s_add_u32 m0, s45, 112640
    s_add_u32 s41, s47, 0x38000
    buffer_load_dwordx4 v10, s[8:11], s41 offen  lds
    s_bfe_u32 s54, s43, 0x40000
    s_add_u32 s54, s54, s50
    s_and_b32 s54, s54, 15
    s_lshl_b32 s55, s54, 7
    s_add_u32 s47, s52, s55
    s_lshl_b32 s55, s54, 19
    s_add_u32 s48, s53, s55
    s_add_u32 m0, s45, 16384
    s_add_u32 s41, s48, 0x0
    buffer_load_dwordx4 v12, s[20:23], s41 offen  lds
    s_add_u32 m0, s45, 18432
    s_add_u32 s41, s48, 0x10000
    buffer_load_dwordx4 v13, s[20:23], s41 offen  lds
    s_add_u32 m0, s45, 20480
    s_add_u32 s41, s48, 0x20000
    buffer_load_dwordx4 v12, s[20:23], s41 offen  lds
    s_add_u32 m0, s45, 22528
    s_add_u32 s41, s48, 0x30000
    buffer_load_dwordx4 v13, s[20:23], s41 offen  lds
    s_waitcnt vmcnt(20)
    s_barrier
    s_add_u32 m0, s45, 24576
    s_add_u32 s41, s48, 0x40000
    buffer_load_dwordx4 v12, s[20:23], s41 offen  lds
    s_add_u32 m0, s45, 26624
    s_add_u32 s41, s48, 0x50000
    buffer_load_dwordx4 v13, s[20:23], s41 offen  lds
    s_add_u32 m0, s45, 28672
    s_add_u32 s41, s48, 0x60000
    buffer_load_dwordx4 v12, s[20:23], s41 offen  lds
    s_add_u32 m0, s45, 30720
    s_add_u32 s41, s48, 0x70000
    buffer_load_dwordx4 v13, s[20:23], s41 offen  lds
    s_add_u32 m0, s45, 0
    s_add_u32 s41, s47, 0x0
    buffer_load_dwordx4 v10, s[8:11], s41 offen  lds
    s_add_u32 m0, s45, 2048
    s_add_u32 s41, s47, 0x8000
    buffer_load_dwordx4 v10, s[8:11], s41 offen  lds
    s_add_u32 m0, s45, 4096
    s_add_u32 s41, s47, 0x10000
    buffer_load_dwordx4 v10, s[8:11], s41 offen  lds
    s_add_u32 m0, s45, 6144
    s_add_u32 s41, s47, 0x18000
    buffer_load_dwordx4 v10, s[8:11], s41 offen  lds
    s_add_u32 m0, s45, 8192
    s_add_u32 s41, s47, 0x20000
    buffer_load_dwordx4 v10, s[8:11], s41 offen  lds
    s_add_u32 m0, s45, 10240
    s_add_u32 s41, s47, 0x28000
    buffer_load_dwordx4 v10, s[8:11], s41 offen  lds
    s_add_u32 m0, s45, 12288
    s_add_u32 s41, s47, 0x30000
    buffer_load_dwordx4 v10, s[8:11], s41 offen  lds
    s_add_u32 m0, s45, 14336
    s_add_u32 s41, s47, 0x38000
    buffer_load_dwordx4 v10, s[8:11], s41 offen  lds
    s_bfe_u32 s54, s43, 0x40004
    s_add_u32 s54, s54, s50
    s_and_b32 s54, s54, 15
    s_lshl_b32 s55, s54, 7
    s_add_u32 s47, s52, s55
    s_lshl_b32 s55, s54, 19
    s_add_u32 s48, s53, s55
    s_add_u32 m0, s45, 49152
    s_add_u32 s41, s48, 0x0
    buffer_load_dwordx4 v12, s[20:23], s41 offen  lds
    s_add_u32 m0, s45, 51200
    s_add_u32 s41, s48, 0x10000
    buffer_load_dwordx4 v13, s[20:23], s41 offen  lds
    s_add_u32 m0, s45, 53248
    s_add_u32 s41, s48, 0x20000
    buffer_load_dwordx4 v12, s[20:23], s41 offen  lds
    s_add_u32 m0, s45, 55296
    s_add_u32 s41, s48, 0x30000
    buffer_load_dwordx4 v13, s[20:23], s41 offen  lds
    s_waitcnt vmcnt(20)
    s_barrier
    s_add_u32 m0, s45, 57344
    s_add_u32 s41, s48, 0x40000
    buffer_load_dwordx4 v12, s[20:23], s41 offen  lds
    s_add_u32 m0, s45, 59392
    s_add_u32 s41, s48, 0x50000
    buffer_load_dwordx4 v13, s[20:23], s41 offen  lds
    s_add_u32 m0, s45, 61440
    s_add_u32 s41, s48, 0x60000
    buffer_load_dwordx4 v12, s[20:23], s41 offen  lds
    s_add_u32 m0, s45, 63488
    s_add_u32 s41, s48, 0x70000
    buffer_load_dwordx4 v13, s[20:23], s41 offen  lds
    s_add_u32 m0, s45, 32768
    s_add_u32 s41, s47, 0x0
    buffer_load_dwordx4 v10, s[8:11], s41 offen  lds
    s_add_u32 m0, s45, 34816
    s_add_u32 s41, s47, 0x8000
    buffer_load_dwordx4 v10, s[8:11], s41 offen  lds
    s_add_u32 m0, s45, 36864
    s_add_u32 s41, s47, 0x10000
    buffer_load_dwordx4 v10, s[8:11], s41 offen  lds
    s_add_u32 m0, s45, 38912
    s_add_u32 s41, s47, 0x18000
    buffer_load_dwordx4 v10, s[8:11], s41 offen  lds
    s_add_u32 m0, s45, 40960
    s_add_u32 s41, s47, 0x20000
    buffer_load_dwordx4 v10, s[8:11], s41 offen  lds
    s_add_u32 m0, s45, 43008
    s_add_u32 s41, s47, 0x28000
    buffer_load_dwordx4 v10, s[8:11], s41 offen  lds
    s_add_u32 m0, s45, 45056
    s_add_u32 s41, s47, 0x30000
    buffer_load_dwordx4 v10, s[8:11], s41 offen  lds
    s_add_u32 m0, s45, 47104
    s_add_u32 s41, s47, 0x38000
    buffer_load_dwordx4 v10, s[8:11], s41 offen  lds
    s_bfe_u32 s54, s43, 0x40008
    s_add_u32 s54, s54, s50
    s_and_b32 s54, s54, 15
    s_lshl_b32 s55, s54, 7
    s_add_u32 s47, s52, s55
    s_lshl_b32 s55, s54, 19
    s_add_u32 s48, s53, s55
    s_add_u32 m0, s45, 81920
    s_add_u32 s41, s48, 0x0
    buffer_load_dwordx4 v12, s[20:23], s41 offen  lds
    s_add_u32 m0, s45, 83968
    s_add_u32 s41, s48, 0x10000
    buffer_load_dwordx4 v13, s[20:23], s41 offen  lds
    s_add_u32 m0, s45, 86016
    s_add_u32 s41, s48, 0x20000
    buffer_load_dwordx4 v12, s[20:23], s41 offen  lds
    s_add_u32 m0, s45, 88064
    s_add_u32 s41, s48, 0x30000
    buffer_load_dwordx4 v13, s[20:23], s41 offen  lds
    s_waitcnt vmcnt(20)
    s_barrier
    s_add_u32 m0, s45, 90112
    s_add_u32 s41, s48, 0x40000
    buffer_load_dwordx4 v12, s[20:23], s41 offen  lds
    s_add_u32 m0, s45, 92160
    s_add_u32 s41, s48, 0x50000
    buffer_load_dwordx4 v13, s[20:23], s41 offen  lds
    s_add_u32 m0, s45, 94208
    s_add_u32 s41, s48, 0x60000
    buffer_load_dwordx4 v12, s[20:23], s41 offen  lds
    s_add_u32 m0, s45, 96256
    s_add_u32 s41, s48, 0x70000
    buffer_load_dwordx4 v13, s[20:23], s41 offen  lds
    s_add_u32 m0, s45, 65536
    s_add_u32 s41, s47, 0x0
    buffer_load_dwordx4 v10, s[8:11], s41 offen  lds
    s_add_u32 m0, s45, 67584
    s_add_u32 s41, s47, 0x8000
    buffer_load_dwordx4 v10, s[8:11], s41 offen  lds
    s_add_u32 m0, s45, 69632
    s_add_u32 s41, s47, 0x10000
    buffer_load_dwordx4 v10, s[8:11], s41 offen  lds
    s_add_u32 m0, s45, 71680
    s_add_u32 s41, s47, 0x18000
    buffer_load_dwordx4 v10, s[8:11], s41 offen  lds
    s_add_u32 m0, s45, 73728
    s_add_u32 s41, s47, 0x20000
    buffer_load_dwordx4 v10, s[8:11], s41 offen  lds
    s_add_u32 m0, s45, 75776
    s_add_u32 s41, s47, 0x28000
    buffer_load_dwordx4 v10, s[8:11], s41 offen  lds
    s_add_u32 m0, s45, 77824
    s_add_u32 s41, s47, 0x30000
    buffer_load_dwordx4 v10, s[8:11], s41 offen  lds
    s_add_u32 m0, s45, 79872
    s_add_u32 s41, s47, 0x38000
    buffer_load_dwordx4 v10, s[8:11], s41 offen  lds
    s_bfe_u32 s54, s43, 0x4000c
    s_add_u32 s54, s54, s50
    s_and_b32 s54, s54, 15
    s_lshl_b32 s55, s54, 7
    s_add_u32 s47, s52, s55
    s_lshl_b32 s55, s54, 19
    s_add_u32 s48, s53, s55
    s_add_u32 m0, s45, 114688
    s_add_u32 s41, s48, 0x0
    buffer_load_dwordx4 v12, s[20:23], s41 offen  lds
    s_add_u32 m0, s45, 116736
    s_add_u32 s41, s48, 0x10000
    buffer_load_dwordx4 v13, s[20:23], s41 offen  lds
    s_add_u32 m0, s45, 118784
    s_add_u32 s41, s48, 0x20000
    buffer_load_dwordx4 v12, s[20:23], s41 offen  lds
    s_add_u32 m0, s45, 120832
    s_add_u32 s41, s48, 0x30000
    buffer_load_dwordx4 v13, s[20:23], s41 offen  lds
    s_waitcnt vmcnt(20)
    s_barrier
    s_add_u32 m0, s45, 122880
    s_add_u32 s41, s48, 0x40000
    buffer_load_dwordx4 v12, s[20:23], s41 offen  lds
    s_add_u32 m0, s45, 124928
    s_add_u32 s41, s48, 0x50000
    buffer_load_dwordx4 v13, s[20:23], s41 offen  lds
    s_add_u32 m0, s45, 126976
    s_add_u32 s41, s48, 0x60000
    buffer_load_dwordx4 v12, s[20:23], s41 offen  lds
    s_add_u32 m0, s45, 129024
    s_add_u32 s41, s48, 0x70000
    buffer_load_dwordx4 v13, s[20:23], s41 offen  lds
    s_add_u32 m0, s45, 98304
    s_add_u32 s41, s47, 0x0
    buffer_load_dwordx4 v10, s[8:11], s41 offen  lds
    s_add_u32 m0, s45, 100352
    s_add_u32 s41, s47, 0x8000
    buffer_load_dwordx4 v10, s[8:11], s41 offen  lds
    s_add_u32 m0, s45, 102400
    s_add_u32 s41, s47, 0x10000
    buffer_load_dwordx4 v10, s[8:11], s41 offen  lds
    s_add_u32 m0, s45, 104448
    s_add_u32 s41, s47, 0x18000
    buffer_load_dwordx4 v10, s[8:11], s41 offen  lds
    s_add_u32 m0, s45, 106496
    s_add_u32 s41, s47, 0x20000
    buffer_load_dwordx4 v10, s[8:11], s41 offen  lds
    s_add_u32 m0, s45, 108544
    s_add_u32 s41, s47, 0x28000
    buffer_load_dwordx4 v10, s[8:11], s41 offen  lds
    s_add_u32 m0, s45, 110592
    s_add_u32 s41, s47, 0x30000
    buffer_load_dwordx4 v10, s[8:11], s41 offen  lds
    s_add_u32 m0, s45, 112640
    s_add_u32 s41, s47, 0x38000
    buffer_load_dwordx4 v10, s[8:11], s41 offen  lds
    s_bfe_u32 s54, s43, 0x40010
    s_add_u32 s54, s54, s50
    s_and_b32 s54, s54, 15
    s_lshl_b32 s55, s54, 7
    s_add_u32 s47, s52, s55
    s_lshl_b32 s55, s54, 19
    s_add_u32 s48, s53, s55
    s_add_u32 m0, s45, 16384
    s_add_u32 s41, s48, 0x0
    buffer_load_dwordx4 v12, s[20:23], s41 offen  lds
    s_add_u32 m0, s45, 18432
    s_add_u32 s41, s48, 0x10000
    buffer_load_dwordx4 v13, s[20:23], s41 offen  lds
    s_add_u32 m0, s45, 20480
    s_add_u32 s41, s48, 0x20000
    buffer_load_dwordx4 v12, s[20:23], s41 offen  lds
    s_add_u32 m0, s45, 22528
    s_add_u32 s41, s48, 0x30000
    buffer_load_dwordx4 v13, s[20:23], s41 offen  lds
    s_waitcnt vmcnt(20)
    s_barrier
    s_add_u32 m0, s45, 24576
    s_add_u32 s41, s48, 0x40000
    buffer_load_dwordx4 v12, s[20:23], s41 offen  lds
    s_add_u32 m0, s45, 26624
    s_add_u32 s41, s48, 0x50000
    buffer_load_dwordx4 v13, s[20:23], s41 offen  lds
    s_add_u32 m0, s45, 28672
    s_add_u32 s41, s48, 0x60000
    buffer_load_dwordx4 v12, s[20:23], s41 offen  lds
    s_add_u32 m0, s45, 30720
    s_add_u32 s41, s48, 0x70000
    buffer_load_dwordx4 v13, s[20:23], s41 offen  lds
    s_add_u32 m0, s45, 139264
    s_add_u32 s41, s57, 0x80000
    buffer_load_dwordx4 v11, s[12:15], s41 offen  lds
    s_add_u32 m0, s45, 155648
    s_add_u32 s41, s57, 0x80080
    buffer_load_dwordx4 v11, s[12:15], s41 offen  lds
    s_add_u32 m0, s45, 141312
    s_add_u32 s41, s57, 0x81000
    buffer_load_dwordx4 v11, s[12:15], s41 offen  lds
    s_add_u32 m0, s45, 157696
    s_add_u32 s41, s57, 0x81080
    buffer_load_dwordx4 v11, s[12:15], s41 offen  lds
    s_add_u32 m0, s45, 143360
    s_add_u32 s41, s57, 0xc0000
    buffer_load_dwordx4 v11, s[12:15], s41 offen  lds
    s_add_u32 m0, s45, 159744
    s_add_u32 s41, s57, 0xc0080
    buffer_load_dwordx4 v11, s[12:15], s41 offen  lds
    s_add_u32 m0, s45, 145408
    s_add_u32 s41, s57, 0xc1000
    buffer_load_dwordx4 v11, s[12:15], s41 offen  lds
    s_add_u32 m0, s45, 161792
    s_add_u32 s41, s57, 0xc1080
    buffer_load_dwordx4 v11, s[12:15], s41 offen  lds
    s_add_u32 m0, s45, 0
    s_add_u32 s41, s47, 0x0
    buffer_load_dwordx4 v10, s[8:11], s41 offen  lds
    s_add_u32 m0, s45, 2048
    s_add_u32 s41, s47, 0x8000
    buffer_load_dwordx4 v10, s[8:11], s41 offen  lds
    s_add_u32 m0, s45, 4096
    s_add_u32 s41, s47, 0x10000
    buffer_load_dwordx4 v10, s[8:11], s41 offen  lds
    s_add_u32 m0, s45, 6144
    s_add_u32 s41, s47, 0x18000
    buffer_load_dwordx4 v10, s[8:11], s41 offen  lds
    s_add_u32 m0, s45, 8192
    s_add_u32 s41, s47, 0x20000
    buffer_load_dwordx4 v10, s[8:11], s41 offen  lds
    s_add_u32 m0, s45, 10240
    s_add_u32 s41, s47, 0x28000
    buffer_load_dwordx4 v10, s[8:11], s41 offen  lds
    s_add_u32 m0, s45, 12288
    s_add_u32 s41, s47, 0x30000
    buffer_load_dwordx4 v10, s[8:11], s41 offen  lds
    s_add_u32 m0, s45, 14336
    s_add_u32 s41, s47, 0x38000
    buffer_load_dwordx4 v10, s[8:11], s41 offen  lds
    s_bfe_u32 s54, s43, 0x40014
    s_add_u32 s54, s54, s50
    s_and_b32 s54, s54, 15
    s_lshl_b32 s55, s54, 7
    s_add_u32 s47, s52, s55
    s_lshl_b32 s55, s54, 19
    s_add_u32 s48, s53, s55
    s_add_u32 m0, s45, 49152
    s_add_u32 s41, s48, 0x0
    buffer_load_dwordx4 v12, s[20:23], s41 offen  lds
    s_add_u32 m0, s45, 51200
    s_add_u32 s41, s48, 0x10000
    buffer_load_dwordx4 v13, s[20:23], s41 offen  lds
    s_add_u32 m0, s45, 53248
    s_add_u32 s41, s48, 0x20000
    buffer_load_dwordx4 v12, s[20:23], s41 offen  lds
    s_add_u32 m0, s45, 55296
    s_add_u32 s41, s48, 0x30000
    buffer_load_dwordx4 v13, s[20:23], s41 offen  lds
    s_waitcnt vmcnt(28)
    s_barrier
    s_add_u32 m0, s45, 57344
    s_add_u32 s41, s48, 0x40000
    buffer_load_dwordx4 v12, s[20:23], s41 offen  lds
    s_add_u32 m0, s45, 59392
    s_add_u32 s41, s48, 0x50000
    buffer_load_dwordx4 v13, s[20:23], s41 offen  lds
    s_add_u32 m0, s45, 61440
    s_add_u32 s41, s48, 0x60000
    buffer_load_dwordx4 v12, s[20:23], s41 offen  lds
    s_add_u32 m0, s45, 63488
    s_add_u32 s41, s48, 0x70000
    buffer_load_dwordx4 v13, s[20:23], s41 offen  lds
    s_add_u32 m0, s45, 32768
    s_add_u32 s41, s47, 0x0
    buffer_load_dwordx4 v10, s[8:11], s41 offen  lds
    s_add_u32 m0, s45, 34816
    s_add_u32 s41, s47, 0x8000
    buffer_load_dwordx4 v10, s[8:11], s41 offen  lds
    s_add_u32 m0, s45, 36864
    s_add_u32 s41, s47, 0x10000
    buffer_load_dwordx4 v10, s[8:11], s41 offen  lds
    s_add_u32 m0, s45, 38912
    s_add_u32 s41, s47, 0x18000
    buffer_load_dwordx4 v10, s[8:11], s41 offen  lds
    s_add_u32 m0, s45, 40960
    s_add_u32 s41, s47, 0x20000
    buffer_load_dwordx4 v10, s[8:11], s41 offen  lds
    s_add_u32 m0, s45, 43008
    s_add_u32 s41, s47, 0x28000
    buffer_load_dwordx4 v10, s[8:11], s41 offen  lds
    s_add_u32 m0, s45, 45056
    s_add_u32 s41, s47, 0x30000
    buffer_load_dwordx4 v10, s[8:11], s41 offen  lds
    s_add_u32 m0, s45, 47104
    s_add_u32 s41, s47, 0x38000
    buffer_load_dwordx4 v10, s[8:11], s41 offen  lds
    s_bfe_u32 s54, s43, 0x40018
    s_add_u32 s54, s54, s50
    s_and_b32 s54, s54, 15
    s_lshl_b32 s55, s54, 7
    s_add_u32 s47, s52, s55
    s_lshl_b32 s55, s54, 19
    s_add_u32 s48, s53, s55
    s_add_u32 m0, s45, 81920
    s_add_u32 s41, s48, 0x0
    buffer_load_dwordx4 v12, s[20:23], s41 offen  lds
    s_add_u32 m0, s45, 83968
    s_add_u32 s41, s48, 0x10000
    buffer_load_dwordx4 v13, s[20:23], s41 offen  lds
    s_add_u32 m0, s45, 86016
    s_add_u32 s41, s48, 0x20000
    buffer_load_dwordx4 v12, s[20:23], s41 offen  lds
    s_add_u32 m0, s45, 88064
    s_add_u32 s41, s48, 0x30000
    buffer_load_dwordx4 v13, s[20:23], s41 offen  lds
    s_waitcnt vmcnt(20)
    s_barrier
    s_add_u32 m0, s45, 90112
    s_add_u32 s41, s48, 0x40000
    buffer_load_dwordx4 v12, s[20:23], s41 offen  lds
    s_add_u32 m0, s45, 92160
    s_add_u32 s41, s48, 0x50000
    buffer_load_dwordx4 v13, s[20:23], s41 offen  lds
    s_add_u32 m0, s45, 94208
    s_add_u32 s41, s48, 0x60000
    buffer_load_dwordx4 v12, s[20:23], s41 offen  lds
    s_add_u32 m0, s45, 96256
    s_add_u32 s41, s48, 0x70000
    buffer_load_dwordx4 v13, s[20:23], s41 offen  lds
    s_add_u32 m0, s45, 65536
    s_add_u32 s41, s47, 0x0
    buffer_load_dwordx4 v10, s[8:11], s41 offen  lds
    s_add_u32 m0, s45, 67584
    s_add_u32 s41, s47, 0x8000
    buffer_load_dwordx4 v10, s[8:11], s41 offen  lds
    s_add_u32 m0, s45, 69632
    s_add_u32 s41, s47, 0x10000
    buffer_load_dwordx4 v10, s[8:11], s41 offen  lds
    s_add_u32 m0, s45, 71680
    s_add_u32 s41, s47, 0x18000
    buffer_load_dwordx4 v10, s[8:11], s41 offen  lds
    s_add_u32 m0, s45, 73728
    s_add_u32 s41, s47, 0x20000
    buffer_load_dwordx4 v10, s[8:11], s41 offen  lds
    s_add_u32 m0, s45, 75776
    s_add_u32 s41, s47, 0x28000
    buffer_load_dwordx4 v10, s[8:11], s41 offen  lds
    s_add_u32 m0, s45, 77824
    s_add_u32 s41, s47, 0x30000
    buffer_load_dwordx4 v10, s[8:11], s41 offen  lds
    s_add_u32 m0, s45, 79872
    s_add_u32 s41, s47, 0x38000
    buffer_load_dwordx4 v10, s[8:11], s41 offen  lds
    s_bfe_u32 s54, s43, 0x4001c
    s_add_u32 s54, s54, s50
    s_and_b32 s54, s54, 15
    s_lshl_b32 s55, s54, 7
    s_add_u32 s47, s52, s55
    s_lshl_b32 s55, s54, 19
    s_add_u32 s48, s53, s55
    s_add_u32 m0, s45, 114688
    s_add_u32 s41, s48, 0x0
    buffer_load_dwordx4 v12, s[20:23], s41 offen  lds
    s_add_u32 m0, s45, 116736
    s_add_u32 s41, s48, 0x10000
    buffer_load_dwordx4 v13, s[20:23], s41 offen  lds
    s_add_u32 m0, s45, 118784
    s_add_u32 s41, s48, 0x20000
    buffer_load_dwordx4 v12, s[20:23], s41 offen  lds
    s_add_u32 m0, s45, 120832
    s_add_u32 s41, s48, 0x30000
    buffer_load_dwordx4 v13, s[20:23], s41 offen  lds
    s_waitcnt vmcnt(20)
    s_barrier
    s_add_u32 m0, s45, 122880
    s_add_u32 s41, s48, 0x40000
    buffer_load_dwordx4 v12, s[20:23], s41 offen  lds
    s_add_u32 m0, s45, 124928
    s_add_u32 s41, s48, 0x50000
    buffer_load_dwordx4 v13, s[20:23], s41 offen  lds
    s_add_u32 m0, s45, 126976
    s_add_u32 s41, s48, 0x60000
    buffer_load_dwordx4 v12, s[20:23], s41 offen  lds
    s_add_u32 m0, s45, 129024
    s_add_u32 s41, s48, 0x70000
    buffer_load_dwordx4 v13, s[20:23], s41 offen  lds
    s_add_u32 m0, s45, 98304
    s_add_u32 s41, s47, 0x0
    buffer_load_dwordx4 v10, s[8:11], s41 offen  lds
    s_add_u32 m0, s45, 100352
    s_add_u32 s41, s47, 0x8000
    buffer_load_dwordx4 v10, s[8:11], s41 offen  lds
    s_add_u32 m0, s45, 102400
    s_add_u32 s41, s47, 0x10000
    buffer_load_dwordx4 v10, s[8:11], s41 offen  lds
    s_add_u32 m0, s45, 104448
    s_add_u32 s41, s47, 0x18000
    buffer_load_dwordx4 v10, s[8:11], s41 offen  lds
    s_add_u32 m0, s45, 106496
    s_add_u32 s41, s47, 0x20000
    buffer_load_dwordx4 v10, s[8:11], s41 offen  lds
    s_add_u32 m0, s45, 108544
    s_add_u32 s41, s47, 0x28000
    buffer_load_dwordx4 v10, s[8:11], s41 offen  lds
    s_add_u32 m0, s45, 110592
    s_add_u32 s41, s47, 0x30000
    buffer_load_dwordx4 v10, s[8:11], s41 offen  lds
    s_add_u32 m0, s45, 112640
    s_add_u32 s41, s47, 0x38000
    buffer_load_dwordx4 v10, s[8:11], s41 offen  lds
    s_bfe_u32 s54, s46, 0x40000
    s_lshl_b32 s55, s54, 13
    s_add_u32 s47, s58, s55
    s_lshl_b32 s55, s54, 18
    s_add_u32 s48, s59, s55
    s_add_u32 m0, s45, 16384
    s_add_u32 s41, s48, 0x0
    buffer_load_dwordx4 v14, s[24:27], s41 offen  lds
    s_add_u32 m0, s45, 18432
    s_add_u32 s41, s48, 0x4000
    buffer_load_dwordx4 v15, s[24:27], s41 offen  lds
    s_add_u32 m0, s45, 20480
    s_add_u32 s41, s48, 0x8000
    buffer_load_dwordx4 v14, s[24:27], s41 offen  lds
    s_add_u32 m0, s45, 22528
    s_add_u32 s41, s48, 0xc000
    buffer_load_dwordx4 v15, s[24:27], s41 offen  lds
    s_waitcnt vmcnt(20)
    s_barrier
    s_add_u32 m0, s45, 24576
    s_add_u32 s41, s48, 0x10000
    buffer_load_dwordx4 v14, s[24:27], s41 offen  lds
    s_add_u32 m0, s45, 26624
    s_add_u32 s41, s48, 0x14000
    buffer_load_dwordx4 v15, s[24:27], s41 offen  lds
    s_add_u32 m0, s45, 28672
    s_add_u32 s41, s48, 0x18000
    buffer_load_dwordx4 v14, s[24:27], s41 offen  lds
    s_add_u32 m0, s45, 30720
    s_add_u32 s41, s48, 0x1c000
    buffer_load_dwordx4 v15, s[24:27], s41 offen  lds
    s_add_u32 m0, s45, 0
    s_add_u32 s41, s47, 0x0
    buffer_load_dwordx4 v11, s[16:19], s41 offen  lds
    s_add_u32 m0, s45, 2048
    s_add_u32 s41, s47, 0x1000
    buffer_load_dwordx4 v11, s[16:19], s41 offen  lds
    s_add_u32 m0, s45, 4096
    s_add_u32 s41, s47, 0x40000
    buffer_load_dwordx4 v11, s[16:19], s41 offen  lds
    s_add_u32 m0, s45, 6144
    s_add_u32 s41, s47, 0x41000
    buffer_load_dwordx4 v11, s[16:19], s41 offen  lds
    s_add_u32 m0, s45, 8192
    s_add_u32 s41, s47, 0x80000
    buffer_load_dwordx4 v11, s[16:19], s41 offen  lds
    s_add_u32 m0, s45, 10240
    s_add_u32 s41, s47, 0x81000
    buffer_load_dwordx4 v11, s[16:19], s41 offen  lds
    s_add_u32 m0, s45, 12288
    s_add_u32 s41, s47, 0xc0000
    buffer_load_dwordx4 v11, s[16:19], s41 offen  lds
    s_add_u32 m0, s45, 14336
    s_add_u32 s41, s47, 0xc1000
    buffer_load_dwordx4 v11, s[16:19], s41 offen  lds
    s_add_u32 m0, s45, 49152
    s_add_u32 s41, s48, 0x20000
    buffer_load_dwordx4 v14, s[24:27], s41 offen  lds
    s_add_u32 m0, s45, 51200
    s_add_u32 s41, s48, 0x24000
    buffer_load_dwordx4 v15, s[24:27], s41 offen  lds
    s_add_u32 m0, s45, 53248
    s_add_u32 s41, s48, 0x28000
    buffer_load_dwordx4 v14, s[24:27], s41 offen  lds
    s_add_u32 m0, s45, 55296
    s_add_u32 s41, s48, 0x2c000
    buffer_load_dwordx4 v15, s[24:27], s41 offen  lds
    s_waitcnt vmcnt(20)
    s_barrier
    s_add_u32 m0, s45, 57344
    s_add_u32 s41, s48, 0x30000
    buffer_load_dwordx4 v14, s[24:27], s41 offen  lds
    s_add_u32 m0, s45, 59392
    s_add_u32 s41, s48, 0x34000
    buffer_load_dwordx4 v15, s[24:27], s41 offen  lds
    s_add_u32 m0, s45, 61440
    s_add_u32 s41, s48, 0x38000
    buffer_load_dwordx4 v14, s[24:27], s41 offen  lds
    s_add_u32 m0, s45, 63488
    s_add_u32 s41, s48, 0x3c000
    buffer_load_dwordx4 v15, s[24:27], s41 offen  lds
    s_add_u32 m0, s45, 32768
    s_add_u32 s41, s47, 0x80
    buffer_load_dwordx4 v11, s[16:19], s41 offen  lds
    s_add_u32 m0, s45, 34816
    s_add_u32 s41, s47, 0x1080
    buffer_load_dwordx4 v11, s[16:19], s41 offen  lds
    s_add_u32 m0, s45, 36864
    s_add_u32 s41, s47, 0x40080
    buffer_load_dwordx4 v11, s[16:19], s41 offen  lds
    s_add_u32 m0, s45, 38912
    s_add_u32 s41, s47, 0x41080
    buffer_load_dwordx4 v11, s[16:19], s41 offen  lds
    s_add_u32 m0, s45, 40960
    s_add_u32 s41, s47, 0x80080
    buffer_load_dwordx4 v11, s[16:19], s41 offen  lds
    s_add_u32 m0, s45, 43008
    s_add_u32 s41, s47, 0x81080
    buffer_load_dwordx4 v11, s[16:19], s41 offen  lds
    s_add_u32 m0, s45, 45056
    s_add_u32 s41, s47, 0xc0080
    buffer_load_dwordx4 v11, s[16:19], s41 offen  lds
    s_add_u32 m0, s45, 47104
    s_add_u32 s41, s47, 0xc1080
    buffer_load_dwordx4 v11, s[16:19], s41 offen  lds
    s_bfe_u32 s54, s46, 0x40004
    s_lshl_b32 s55, s54, 13
    s_add_u32 s47, s58, s55
    s_lshl_b32 s55, s54, 18
    s_add_u32 s48, s59, s55
    s_add_u32 m0, s45, 81920
    s_add_u32 s41, s48, 0x0
    buffer_load_dwordx4 v14, s[24:27], s41 offen  lds
    s_add_u32 m0, s45, 83968
    s_add_u32 s41, s48, 0x4000
    buffer_load_dwordx4 v15, s[24:27], s41 offen  lds
    s_add_u32 m0, s45, 86016
    s_add_u32 s41, s48, 0x8000
    buffer_load_dwordx4 v14, s[24:27], s41 offen  lds
    s_add_u32 m0, s45, 88064
    s_add_u32 s41, s48, 0xc000
    buffer_load_dwordx4 v15, s[24:27], s41 offen  lds
    s_waitcnt vmcnt(20)
    s_barrier
    s_add_u32 m0, s45, 90112
    s_add_u32 s41, s48, 0x10000
    buffer_load_dwordx4 v14, s[24:27], s41 offen  lds
    s_add_u32 m0, s45, 92160
    s_add_u32 s41, s48, 0x14000
    buffer_load_dwordx4 v15, s[24:27], s41 offen  lds
    s_add_u32 m0, s45, 94208
    s_add_u32 s41, s48, 0x18000
    buffer_load_dwordx4 v14, s[24:27], s41 offen  lds
    s_add_u32 m0, s45, 96256
    s_add_u32 s41, s48, 0x1c000
    buffer_load_dwordx4 v15, s[24:27], s41 offen  lds
    s_add_u32 m0, s45, 65536
    s_add_u32 s41, s47, 0x0
    buffer_load_dwordx4 v11, s[16:19], s41 offen  lds
    s_add_u32 m0, s45, 67584
    s_add_u32 s41, s47, 0x1000
    buffer_load_dwordx4 v11, s[16:19], s41 offen  lds
    s_add_u32 m0, s45, 69632
    s_add_u32 s41, s47, 0x40000
    buffer_load_dwordx4 v11, s[16:19], s41 offen  lds
    s_add_u32 m0, s45, 71680
    s_add_u32 s41, s47, 0x41000
    buffer_load_dwordx4 v11, s[16:19], s41 offen  lds
    s_add_u32 m0, s45, 73728
    s_add_u32 s41, s47, 0x80000
    buffer_load_dwordx4 v11, s[16:19], s41 offen  lds
    s_add_u32 m0, s45, 75776
    s_add_u32 s41, s47, 0x81000
    buffer_load_dwordx4 v11, s[16:19], s41 offen  lds
    s_add_u32 m0, s45, 77824
    s_add_u32 s41, s47, 0xc0000
    buffer_load_dwordx4 v11, s[16:19], s41 offen  lds
    s_add_u32 m0, s45, 79872
    s_add_u32 s41, s47, 0xc1000
    buffer_load_dwordx4 v11, s[16:19], s41 offen  lds
    s_add_u32 m0, s45, 114688
    s_add_u32 s41, s48, 0x20000
    buffer_load_dwordx4 v14, s[24:27], s41 offen  lds
    s_add_u32 m0, s45, 116736
    s_add_u32 s41, s48, 0x24000
    buffer_load_dwordx4 v15, s[24:27], s41 offen  lds
    s_add_u32 m0, s45, 118784
    s_add_u32 s41, s48, 0x28000
    buffer_load_dwordx4 v14, s[24:27], s41 offen  lds
    s_add_u32 m0, s45, 120832
    s_add_u32 s41, s48, 0x2c000
    buffer_load_dwordx4 v15, s[24:27], s41 offen  lds
    s_waitcnt vmcnt(20)
    s_barrier
    s_add_u32 m0, s45, 122880
    s_add_u32 s41, s48, 0x30000
    buffer_load_dwordx4 v14, s[24:27], s41 offen  lds
    s_add_u32 m0, s45, 124928
    s_add_u32 s41, s48, 0x34000
    buffer_load_dwordx4 v15, s[24:27], s41 offen  lds
    s_add_u32 m0, s45, 126976
    s_add_u32 s41, s48, 0x38000
    buffer_load_dwordx4 v14, s[24:27], s41 offen  lds
    s_add_u32 m0, s45, 129024
    s_add_u32 s41, s48, 0x3c000
    buffer_load_dwordx4 v15, s[24:27], s41 offen  lds
    s_add_u32 m0, s45, 98304
    s_add_u32 s41, s47, 0x80
    buffer_load_dwordx4 v11, s[16:19], s41 offen  lds
    s_add_u32 m0, s45, 100352
    s_add_u32 s41, s47, 0x1080
    buffer_load_dwordx4 v11, s[16:19], s41 offen  lds
    s_add_u32 m0, s45, 102400
    s_add_u32 s41, s47, 0x40080
    buffer_load_dwordx4 v11, s[16:19], s41 offen  lds
    s_add_u32 m0, s45, 104448
    s_add_u32 s41, s47, 0x41080
    buffer_load_dwordx4 v11, s[16:19], s41 offen  lds
    s_add_u32 m0, s45, 106496
    s_add_u32 s41, s47, 0x80080
    buffer_load_dwordx4 v11, s[16:19], s41 offen  lds
    s_add_u32 m0, s45, 108544
    s_add_u32 s41, s47, 0x81080
    buffer_load_dwordx4 v11, s[16:19], s41 offen  lds
    s_add_u32 m0, s45, 110592
    s_add_u32 s41, s47, 0xc0080
    buffer_load_dwordx4 v11, s[16:19], s41 offen  lds
    s_add_u32 m0, s45, 112640
    s_add_u32 s41, s47, 0xc1080
    buffer_load_dwordx4 v11, s[16:19], s41 offen  lds
    s_bfe_u32 s54, s46, 0x40008
    s_lshl_b32 s55, s54, 13
    s_add_u32 s47, s58, s55
    s_lshl_b32 s55, s54, 18
    s_add_u32 s48, s59, s55
    s_add_u32 m0, s45, 16384
    s_add_u32 s41, s48, 0x0
    buffer_load_dwordx4 v14, s[24:27], s41 offen  lds
    s_add_u32 m0, s45, 18432
    s_add_u32 s41, s48, 0x4000
    buffer_load_dwordx4 v15, s[24:27], s41 offen  lds
    s_add_u32 m0, s45, 20480
    s_add_u32 s41, s48, 0x8000
    buffer_load_dwordx4 v14, s[24:27], s41 offen  lds
    s_add_u32 m0, s45, 22528
    s_add_u32 s41, s48, 0xc000
    buffer_load_dwordx4 v15, s[24:27], s41 offen  lds
    s_waitcnt vmcnt(20)
    s_barrier
    s_add_u32 m0, s45, 24576
    s_add_u32 s41, s48, 0x10000
    buffer_load_dwordx4 v14, s[24:27], s41 offen  lds
    s_add_u32 m0, s45, 26624
    s_add_u32 s41, s48, 0x14000
    buffer_load_dwordx4 v15, s[24:27], s41 offen  lds
    s_add_u32 m0, s45, 28672
    s_add_u32 s41, s48, 0x18000
    buffer_load_dwordx4 v14, s[24:27], s41 offen  lds
    s_add_u32 m0, s45, 30720
    s_add_u32 s41, s48, 0x1c000
    buffer_load_dwordx4 v15, s[24:27], s41 offen  lds
    s_add_u32 m0, s45, 0
    s_add_u32 s41, s47, 0x0
    buffer_load_dwordx4 v11, s[16:19], s41 offen  lds
    s_add_u32 m0, s45, 2048
    s_add_u32 s41, s47, 0x1000
    buffer_load_dwordx4 v11, s[16:19], s41 offen  lds
    s_add_u32 m0, s45, 4096
    s_add_u32 s41, s47, 0x40000
    buffer_load_dwordx4 v11, s[16:19], s41 offen  lds
    s_add_u32 m0, s45, 6144
    s_add_u32 s41, s47, 0x41000
    buffer_load_dwordx4 v11, s[16:19], s41 offen  lds
    s_add_u32 m0, s45, 8192
    s_add_u32 s41, s47, 0x80000
    buffer_load_dwordx4 v11, s[16:19], s41 offen  lds
    s_add_u32 m0, s45, 10240
    s_add_u32 s41, s47, 0x81000
    buffer_load_dwordx4 v11, s[16:19], s41 offen  lds
    s_add_u32 m0, s45, 12288
    s_add_u32 s41, s47, 0xc0000
    buffer_load_dwordx4 v11, s[16:19], s41 offen  lds
    s_add_u32 m0, s45, 14336
    s_add_u32 s41, s47, 0xc1000
    buffer_load_dwordx4 v11, s[16:19], s41 offen  lds
    s_add_u32 m0, s45, 49152
    s_add_u32 s41, s48, 0x20000
    buffer_load_dwordx4 v14, s[24:27], s41 offen  lds
    s_add_u32 m0, s45, 51200
    s_add_u32 s41, s48, 0x24000
    buffer_load_dwordx4 v15, s[24:27], s41 offen  lds
    s_add_u32 m0, s45, 53248
    s_add_u32 s41, s48, 0x28000
    buffer_load_dwordx4 v14, s[24:27], s41 offen  lds
    s_add_u32 m0, s45, 55296
    s_add_u32 s41, s48, 0x2c000
    buffer_load_dwordx4 v15, s[24:27], s41 offen  lds
    s_waitcnt vmcnt(20)
    s_barrier
    s_add_u32 m0, s45, 57344
    s_add_u32 s41, s48, 0x30000
    buffer_load_dwordx4 v14, s[24:27], s41 offen  lds
    s_add_u32 m0, s45, 59392
    s_add_u32 s41, s48, 0x34000
    buffer_load_dwordx4 v15, s[24:27], s41 offen  lds
    s_add_u32 m0, s45, 61440
    s_add_u32 s41, s48, 0x38000
    buffer_load_dwordx4 v14, s[24:27], s41 offen  lds
    s_add_u32 m0, s45, 63488
    s_add_u32 s41, s48, 0x3c000
    buffer_load_dwordx4 v15, s[24:27], s41 offen  lds
    s_add_u32 m0, s45, 32768
    s_add_u32 s41, s47, 0x80
    buffer_load_dwordx4 v11, s[16:19], s41 offen  lds
    s_add_u32 m0, s45, 34816
    s_add_u32 s41, s47, 0x1080
    buffer_load_dwordx4 v11, s[16:19], s41 offen  lds
    s_add_u32 m0, s45, 36864
    s_add_u32 s41, s47, 0x40080
    buffer_load_dwordx4 v11, s[16:19], s41 offen  lds
    s_add_u32 m0, s45, 38912
    s_add_u32 s41, s47, 0x41080
    buffer_load_dwordx4 v11, s[16:19], s41 offen  lds
    s_add_u32 m0, s45, 40960
    s_add_u32 s41, s47, 0x80080
    buffer_load_dwordx4 v11, s[16:19], s41 offen  lds
    s_add_u32 m0, s45, 43008
    s_add_u32 s41, s47, 0x81080
    buffer_load_dwordx4 v11, s[16:19], s41 offen  lds
    s_add_u32 m0, s45, 45056
    s_add_u32 s41, s47, 0xc0080
    buffer_load_dwordx4 v11, s[16:19], s41 offen  lds
    s_add_u32 m0, s45, 47104
    s_add_u32 s41, s47, 0xc1080
    buffer_load_dwordx4 v11, s[16:19], s41 offen  lds
    s_bfe_u32 s54, s46, 0x4000c
    s_lshl_b32 s55, s54, 13
    s_add_u32 s47, s58, s55
    s_lshl_b32 s55, s54, 18
    s_add_u32 s48, s59, s55
    s_add_u32 m0, s45, 81920
    s_add_u32 s41, s48, 0x0
    buffer_load_dwordx4 v14, s[24:27], s41 offen  lds
    s_add_u32 m0, s45, 83968
    s_add_u32 s41, s48, 0x4000
    buffer_load_dwordx4 v15, s[24:27], s41 offen  lds
    s_add_u32 m0, s45, 86016
    s_add_u32 s41, s48, 0x8000
    buffer_load_dwordx4 v14, s[24:27], s41 offen  lds
    s_add_u32 m0, s45, 88064
    s_add_u32 s41, s48, 0xc000
    buffer_load_dwordx4 v15, s[24:27], s41 offen  lds
    s_waitcnt vmcnt(20)
    s_barrier
    s_add_u32 m0, s45, 90112
    s_add_u32 s41, s48, 0x10000
    buffer_load_dwordx4 v14, s[24:27], s41 offen  lds
    s_add_u32 m0, s45, 92160
    s_add_u32 s41, s48, 0x14000
    buffer_load_dwordx4 v15, s[24:27], s41 offen  lds
    s_add_u32 m0, s45, 94208
    s_add_u32 s41, s48, 0x18000
    buffer_load_dwordx4 v14, s[24:27], s41 offen  lds
    s_add_u32 m0, s45, 96256
    s_add_u32 s41, s48, 0x1c000
    buffer_load_dwordx4 v15, s[24:27], s41 offen  lds
    s_add_u32 m0, s45, 65536
    s_add_u32 s41, s47, 0x0
    buffer_load_dwordx4 v11, s[16:19], s41 offen  lds
    s_add_u32 m0, s45, 67584
    s_add_u32 s41, s47, 0x1000
    buffer_load_dwordx4 v11, s[16:19], s41 offen  lds
    s_add_u32 m0, s45, 69632
    s_add_u32 s41, s47, 0x40000
    buffer_load_dwordx4 v11, s[16:19], s41 offen  lds
    s_add_u32 m0, s45, 71680
    s_add_u32 s41, s47, 0x41000
    buffer_load_dwordx4 v11, s[16:19], s41 offen  lds
    s_add_u32 m0, s45, 73728
    s_add_u32 s41, s47, 0x80000
    buffer_load_dwordx4 v11, s[16:19], s41 offen  lds
    s_add_u32 m0, s45, 75776
    s_add_u32 s41, s47, 0x81000
    buffer_load_dwordx4 v11, s[16:19], s41 offen  lds
    s_add_u32 m0, s45, 77824
    s_add_u32 s41, s47, 0xc0000
    buffer_load_dwordx4 v11, s[16:19], s41 offen  lds
    s_add_u32 m0, s45, 79872
    s_add_u32 s41, s47, 0xc1000
    buffer_load_dwordx4 v11, s[16:19], s41 offen  lds
    s_add_u32 m0, s45, 114688
    s_add_u32 s41, s48, 0x20000
    buffer_load_dwordx4 v14, s[24:27], s41 offen  lds
    s_add_u32 m0, s45, 116736
    s_add_u32 s41, s48, 0x24000
    buffer_load_dwordx4 v15, s[24:27], s41 offen  lds
    s_add_u32 m0, s45, 118784
    s_add_u32 s41, s48, 0x28000
    buffer_load_dwordx4 v14, s[24:27], s41 offen  lds
    s_add_u32 m0, s45, 120832
    s_add_u32 s41, s48, 0x2c000
    buffer_load_dwordx4 v15, s[24:27], s41 offen  lds
    s_waitcnt vmcnt(20)
    s_barrier
    s_bfe_u32 s60, s46, 0x40004
    s_lshl_b32 s60, s60, 13
    s_add_u32 s60, s60, s49
    s_add_u32 m0, s45, 139264
    s_add_u32 s41, s60, 0x0
    buffer_load_dwordx4 v16, s[28:31], s41 offen sc1 lds
    s_add_u32 m0, s45, 141312
    s_add_u32 s41, s60, 0x800
    buffer_load_dwordx4 v16, s[28:31], s41 offen sc1 lds
    s_add_u32 m0, s45, 143360
    s_add_u32 s41, s60, 0x1000
    buffer_load_dwordx4 v16, s[28:31], s41 offen sc1 lds
    s_add_u32 m0, s45, 145408
    s_add_u32 s41, s60, 0x1800
    buffer_load_dwordx4 v16, s[28:31], s41 offen sc1 lds
    s_add_u32 m0, s45, 122880
    s_add_u32 s41, s48, 0x30000
    buffer_load_dwordx4 v14, s[24:27], s41 offen  lds
    s_add_u32 m0, s45, 124928
    s_add_u32 s41, s48, 0x34000
    buffer_load_dwordx4 v15, s[24:27], s41 offen  lds
    s_add_u32 m0, s45, 126976
    s_add_u32 s41, s48, 0x38000
    buffer_load_dwordx4 v14, s[24:27], s41 offen  lds
    s_add_u32 m0, s45, 129024
    s_add_u32 s41, s48, 0x3c000
    buffer_load_dwordx4 v15, s[24:27], s41 offen  lds
    s_add_u32 m0, s45, 98304
    s_add_u32 s41, s47, 0x80
    buffer_load_dwordx4 v11, s[16:19], s41 offen  lds
    s_add_u32 m0, s45, 100352
    s_add_u32 s41, s47, 0x1080
    buffer_load_dwordx4 v11, s[16:19], s41 offen  lds
    s_add_u32 m0, s45, 102400
    s_add_u32 s41, s47, 0x40080
    buffer_load_dwordx4 v11, s[16:19], s41 offen  lds
    s_add_u32 m0, s45, 104448
    s_add_u32 s41, s47, 0x41080
    buffer_load_dwordx4 v11, s[16:19], s41 offen  lds
    s_add_u32 m0, s45, 106496
    s_add_u32 s41, s47, 0x80080
    buffer_load_dwordx4 v11, s[16:19], s41 offen  lds
    s_add_u32 m0, s45, 108544
    s_add_u32 s41, s47, 0x81080
    buffer_load_dwordx4 v11, s[16:19], s41 offen  lds
    s_add_u32 m0, s45, 110592
    s_add_u32 s41, s47, 0xc0080
    buffer_load_dwordx4 v11, s[16:19], s41 offen  lds
    s_add_u32 m0, s45, 112640
    s_add_u32 s41, s47, 0xc1080
    buffer_load_dwordx4 v11, s[16:19], s41 offen  lds
    s_bfe_u32 s54, s46, 0x40010
    s_lshl_b32 s55, s54, 13
    s_add_u32 s47, s58, s55
    s_lshl_b32 s55, s54, 18
    s_add_u32 s48, s59, s55
    s_add_u32 m0, s45, 16384
    s_add_u32 s41, s48, 0x0
    buffer_load_dwordx4 v14, s[24:27], s41 offen  lds
    s_add_u32 m0, s45, 18432
    s_add_u32 s41, s48, 0x4000
    buffer_load_dwordx4 v15, s[24:27], s41 offen  lds
    s_add_u32 m0, s45, 20480
    s_add_u32 s41, s48, 0x8000
    buffer_load_dwordx4 v14, s[24:27], s41 offen  lds
    s_add_u32 m0, s45, 22528
    s_add_u32 s41, s48, 0xc000
    buffer_load_dwordx4 v15, s[24:27], s41 offen  lds
    s_waitcnt vmcnt(16)
    s_barrier
    s_add_u32 m0, s45, 24576
    s_add_u32 s41, s48, 0x10000
    buffer_load_dwordx4 v14, s[24:27], s41 offen  lds
    s_add_u32 m0, s45, 26624
    s_add_u32 s41, s48, 0x14000
    buffer_load_dwordx4 v15, s[24:27], s41 offen  lds
    s_add_u32 m0, s45, 28672
    s_add_u32 s41, s48, 0x18000
    buffer_load_dwordx4 v14, s[24:27], s41 offen  lds
    s_add_u32 m0, s45, 30720
    s_add_u32 s41, s48, 0x1c000
    buffer_load_dwordx4 v15, s[24:27], s41 offen  lds
    s_add_u32 m0, s45, 0
    s_add_u32 s41, s47, 0x0
    buffer_load_dwordx4 v11, s[16:19], s41 offen  lds
    s_add_u32 m0, s45, 2048
    s_add_u32 s41, s47, 0x1000
    buffer_load_dwordx4 v11, s[16:19], s41 offen  lds
    s_add_u32 m0, s45, 4096
    s_add_u32 s41, s47, 0x40000
    buffer_load_dwordx4 v11, s[16:19], s41 offen  lds
    s_add_u32 m0, s45, 6144
    s_add_u32 s41, s47, 0x41000
    buffer_load_dwordx4 v11, s[16:19], s41 offen  lds
    s_add_u32 m0, s45, 8192
    s_add_u32 s41, s47, 0x80000
    buffer_load_dwordx4 v11, s[16:19], s41 offen  lds
    s_add_u32 m0, s45, 10240
    s_add_u32 s41, s47, 0x81000
    buffer_load_dwordx4 v11, s[16:19], s41 offen  lds
    s_add_u32 m0, s45, 12288
    s_add_u32 s41, s47, 0xc0000
    buffer_load_dwordx4 v11, s[16:19], s41 offen  lds
    s_add_u32 m0, s45, 14336
    s_add_u32 s41, s47, 0xc1000
    buffer_load_dwordx4 v11, s[16:19], s41 offen  lds
    s_bfe_u32 s60, s46, 0x40008
    s_lshl_b32 s60, s60, 13
    s_add_u32 s60, s60, s49
    s_add_u32 m0, s45, 147456
    s_add_u32 s41, s60, 0x0
    buffer_load_dwordx4 v16, s[28:31], s41 offen sc1 lds
    s_add_u32 m0, s45, 149504
    s_add_u32 s41, s60, 0x800
    buffer_load_dwordx4 v16, s[28:31], s41 offen sc1 lds
    s_add_u32 m0, s45, 151552
    s_add_u32 s41, s60, 0x1000
    buffer_load_dwordx4 v16, s[28:31], s41 offen sc1 lds
    s_add_u32 m0, s45, 153600
    s_add_u32 s41, s60, 0x1800
    buffer_load_dwordx4 v16, s[28:31], s41 offen sc1 lds
    s_bfe_u32 s60, s46, 0x4000c
    s_lshl_b32 s60, s60, 13
    s_add_u32 s60, s60, s49
    s_add_u32 m0, s45, 155648
    s_add_u32 s41, s60, 0x0
    buffer_load_dwordx4 v16, s[28:31], s41 offen sc1 lds
    s_add_u32 m0, s45, 157696
    s_add_u32 s41, s60, 0x800
    buffer_load_dwordx4 v16, s[28:31], s41 offen sc1 lds
    s_add_u32 m0, s45, 159744
    s_add_u32 s41, s60, 0x1000
    buffer_load_dwordx4 v16, s[28:31], s41 offen sc1 lds
    s_add_u32 m0, s45, 161792
    s_add_u32 s41, s60, 0x1800
    buffer_load_dwordx4 v16, s[28:31], s41 offen sc1 lds
    s_add_u32 m0, s45, 49152
    s_add_u32 s41, s48, 0x20000
    buffer_load_dwordx4 v14, s[24:27], s41 offen  lds
    s_add_u32 m0, s45, 51200
    s_add_u32 s41, s48, 0x24000
    buffer_load_dwordx4 v15, s[24:27], s41 offen  lds
    s_add_u32 m0, s45, 53248
    s_add_u32 s41, s48, 0x28000
    buffer_load_dwordx4 v14, s[24:27], s41 offen  lds
    s_add_u32 m0, s45, 55296
    s_add_u32 s41, s48, 0x2c000
    buffer_load_dwordx4 v15, s[24:27], s41 offen  lds
    s_waitcnt vmcnt(28)
    s_barrier
    s_add_u32 m0, s45, 57344
    s_add_u32 s41, s48, 0x30000
    buffer_load_dwordx4 v14, s[24:27], s41 offen  lds
    s_add_u32 m0, s45, 59392
    s_add_u32 s41, s48, 0x34000
    buffer_load_dwordx4 v15, s[24:27], s41 offen  lds
    s_add_u32 m0, s45, 61440
    s_add_u32 s41, s48, 0x38000
    buffer_load_dwordx4 v14, s[24:27], s41 offen  lds
    s_add_u32 m0, s45, 63488
    s_add_u32 s41, s48, 0x3c000
    buffer_load_dwordx4 v15, s[24:27], s41 offen  lds
    s_add_u32 m0, s45, 32768
    s_add_u32 s41, s47, 0x80
    buffer_load_dwordx4 v11, s[16:19], s41 offen  lds
    s_add_u32 m0, s45, 34816
    s_add_u32 s41, s47, 0x1080
    buffer_load_dwordx4 v11, s[16:19], s41 offen  lds
    s_add_u32 m0, s45, 36864
    s_add_u32 s41, s47, 0x40080
    buffer_load_dwordx4 v11, s[16:19], s41 offen  lds
    s_add_u32 m0, s45, 38912
    s_add_u32 s41, s47, 0x41080
    buffer_load_dwordx4 v11, s[16:19], s41 offen  lds
    s_add_u32 m0, s45, 40960
    s_add_u32 s41, s47, 0x80080
    buffer_load_dwordx4 v11, s[16:19], s41 offen  lds
    s_add_u32 m0, s45, 43008
    s_add_u32 s41, s47, 0x81080
    buffer_load_dwordx4 v11, s[16:19], s41 offen  lds
    s_add_u32 m0, s45, 45056
    s_add_u32 s41, s47, 0xc0080
    buffer_load_dwordx4 v11, s[16:19], s41 offen  lds
    s_add_u32 m0, s45, 47104
    s_add_u32 s41, s47, 0xc1080
    buffer_load_dwordx4 v11, s[16:19], s41 offen  lds
    s_bfe_u32 s54, s46, 0x40014
    s_lshl_b32 s55, s54, 13
    s_add_u32 s47, s58, s55
    s_lshl_b32 s55, s54, 18
    s_add_u32 s48, s59, s55
    s_add_u32 m0, s45, 81920
    s_add_u32 s41, s48, 0x0
    buffer_load_dwordx4 v14, s[24:27], s41 offen  lds
    s_add_u32 m0, s45, 83968
    s_add_u32 s41, s48, 0x4000
    buffer_load_dwordx4 v15, s[24:27], s41 offen  lds
    s_add_u32 m0, s45, 86016
    s_add_u32 s41, s48, 0x8000
    buffer_load_dwordx4 v14, s[24:27], s41 offen  lds
    s_add_u32 m0, s45, 88064
    s_add_u32 s41, s48, 0xc000
    buffer_load_dwordx4 v15, s[24:27], s41 offen  lds
    s_waitcnt vmcnt(24)
    s_barrier
    s_add_u32 m0, s45, 90112
    s_add_u32 s41, s48, 0x10000
    buffer_load_dwordx4 v14, s[24:27], s41 offen  lds
    s_add_u32 m0, s45, 92160
    s_add_u32 s41, s48, 0x14000
    buffer_load_dwordx4 v15, s[24:27], s41 offen  lds
    s_add_u32 m0, s45, 94208
    s_add_u32 s41, s48, 0x18000
    buffer_load_dwordx4 v14, s[24:27], s41 offen  lds
    s_add_u32 m0, s45, 96256
    s_add_u32 s41, s48, 0x1c000
    buffer_load_dwordx4 v15, s[24:27], s41 offen  lds
    s_add_u32 m0, s45, 65536
    s_add_u32 s41, s47, 0x0
    buffer_load_dwordx4 v11, s[16:19], s41 offen  lds
    s_add_u32 m0, s45, 67584
    s_add_u32 s41, s47, 0x1000
    buffer_load_dwordx4 v11, s[16:19], s41 offen  lds
    s_add_u32 m0, s45, 69632
    s_add_u32 s41, s47, 0x40000
    buffer_load_dwordx4 v11, s[16:19], s41 offen  lds
    s_add_u32 m0, s45, 71680
    s_add_u32 s41, s47, 0x41000
    buffer_load_dwordx4 v11, s[16:19], s41 offen  lds
    s_add_u32 m0, s45, 73728
    s_add_u32 s41, s47, 0x80000
    buffer_load_dwordx4 v11, s[16:19], s41 offen  lds
    s_add_u32 m0, s45, 75776
    s_add_u32 s41, s47, 0x81000
    buffer_load_dwordx4 v11, s[16:19], s41 offen  lds
    s_add_u32 m0, s45, 77824
    s_add_u32 s41, s47, 0xc0000
    buffer_load_dwordx4 v11, s[16:19], s41 offen  lds
    s_add_u32 m0, s45, 79872
    s_add_u32 s41, s47, 0xc1000
    buffer_load_dwordx4 v11, s[16:19], s41 offen  lds
    s_bfe_u32 s60, s46, 0x40010
    s_lshl_b32 s60, s60, 13
    s_add_u32 s60, s60, s49
    s_add_u32 m0, s45, 131072
    s_add_u32 s41, s60, 0x0
    buffer_load_dwordx4 v16, s[28:31], s41 offen sc1 lds
    s_add_u32 m0, s45, 133120
    s_add_u32 s41, s60, 0x800
    buffer_load_dwordx4 v16, s[28:31], s41 offen sc1 lds
    s_add_u32 m0, s45, 135168
    s_add_u32 s41, s60, 0x1000
    buffer_load_dwordx4 v16, s[28:31], s41 offen sc1 lds
    s_add_u32 m0, s45, 137216
    s_add_u32 s41, s60, 0x1800
    buffer_load_dwordx4 v16, s[28:31], s41 offen sc1 lds
    s_add_u32 m0, s45, 114688
    s_add_u32 s41, s48, 0x20000
    buffer_load_dwordx4 v14, s[24:27], s41 offen  lds
    s_add_u32 m0, s45, 116736
    s_add_u32 s41, s48, 0x24000
    buffer_load_dwordx4 v15, s[24:27], s41 offen  lds
    s_add_u32 m0, s45, 118784
    s_add_u32 s41, s48, 0x28000
    buffer_load_dwordx4 v14, s[24:27], s41 offen  lds
    s_add_u32 m0, s45, 120832
    s_add_u32 s41, s48, 0x2c000
    buffer_load_dwordx4 v15, s[24:27], s41 offen  lds
    s_waitcnt vmcnt(24)
    s_barrier
    s_add_u32 m0, s45, 122880
    s_add_u32 s41, s48, 0x30000
    buffer_load_dwordx4 v14, s[24:27], s41 offen  lds
    s_add_u32 m0, s45, 124928
    s_add_u32 s41, s48, 0x34000
    buffer_load_dwordx4 v15, s[24:27], s41 offen  lds
    s_add_u32 m0, s45, 126976
    s_add_u32 s41, s48, 0x38000
    buffer_load_dwordx4 v14, s[24:27], s41 offen  lds
    s_add_u32 m0, s45, 129024
    s_add_u32 s41, s48, 0x3c000
    buffer_load_dwordx4 v15, s[24:27], s41 offen  lds
    s_add_u32 m0, s45, 98304
    s_add_u32 s41, s47, 0x80
    buffer_load_dwordx4 v11, s[16:19], s41 offen  lds
    s_add_u32 m0, s45, 100352
    s_add_u32 s41, s47, 0x1080
    buffer_load_dwordx4 v11, s[16:19], s41 offen  lds
    s_add_u32 m0, s45, 102400
    s_add_u32 s41, s47, 0x40080
    buffer_load_dwordx4 v11, s[16:19], s41 offen  lds
    s_add_u32 m0, s45, 104448
    s_add_u32 s41, s47, 0x41080
    buffer_load_dwordx4 v11, s[16:19], s41 offen  lds
    s_add_u32 m0, s45, 106496
    s_add_u32 s41, s47, 0x80080
    buffer_load_dwordx4 v11, s[16:19], s41 offen  lds
    s_add_u32 m0, s45, 108544
    s_add_u32 s41, s47, 0x81080
    buffer_load_dwordx4 v11, s[16:19], s41 offen  lds
    s_add_u32 m0, s45, 110592
    s_add_u32 s41, s47, 0xc0080
    buffer_load_dwordx4 v11, s[16:19], s41 offen  lds
    s_add_u32 m0, s45, 112640
    s_add_u32 s41, s47, 0xc1080
    buffer_load_dwordx4 v11, s[16:19], s41 offen  lds
    s_bfe_u32 s54, s46, 0x40018
    s_lshl_b32 s55, s54, 13
    s_add_u32 s47, s58, s55
    s_lshl_b32 s55, s54, 18
    s_add_u32 s48, s59, s55
    s_add_u32 m0, s45, 16384
    s_add_u32 s41, s48, 0x0
    buffer_load_dwordx4 v14, s[24:27], s41 offen  lds
    s_add_u32 m0, s45, 18432
    s_add_u32 s41, s48, 0x4000
    buffer_load_dwordx4 v15, s[24:27], s41 offen  lds
    s_add_u32 m0, s45, 20480
    s_add_u32 s41, s48, 0x8000
    buffer_load_dwordx4 v14, s[24:27], s41 offen  lds
    s_add_u32 m0, s45, 22528
    s_add_u32 s41, s48, 0xc000
    buffer_load_dwordx4 v15, s[24:27], s41 offen  lds
    s_waitcnt vmcnt(24)
    s_barrier
    s_add_u32 m0, s45, 24576
    s_add_u32 s41, s48, 0x10000
    buffer_load_dwordx4 v14, s[24:27], s41 offen  lds
    s_add_u32 m0, s45, 26624
    s_add_u32 s41, s48, 0x14000
    buffer_load_dwordx4 v15, s[24:27], s41 offen  lds
    s_add_u32 m0, s45, 28672
    s_add_u32 s41, s48, 0x18000
    buffer_load_dwordx4 v14, s[24:27], s41 offen  lds
    s_add_u32 m0, s45, 30720
    s_add_u32 s41, s48, 0x1c000
    buffer_load_dwordx4 v15, s[24:27], s41 offen  lds
    s_add_u32 m0, s45, 0
    s_add_u32 s41, s47, 0x0
    buffer_load_dwordx4 v11, s[16:19], s41 offen  lds
    s_add_u32 m0, s45, 2048
    s_add_u32 s41, s47, 0x1000
    buffer_load_dwordx4 v11, s[16:19], s41 offen  lds
    s_add_u32 m0, s45, 4096
    s_add_u32 s41, s47, 0x40000
    buffer_load_dwordx4 v11, s[16:19], s41 offen  lds
    s_add_u32 m0, s45, 6144
    s_add_u32 s41, s47, 0x41000
    buffer_load_dwordx4 v11, s[16:19], s41 offen  lds
    s_add_u32 m0, s45, 8192
    s_add_u32 s41, s47, 0x80000
    buffer_load_dwordx4 v11, s[16:19], s41 offen  lds
    s_add_u32 m0, s45, 10240
    s_add_u32 s41, s47, 0x81000
    buffer_load_dwordx4 v11, s[16:19], s41 offen  lds
    s_add_u32 m0, s45, 12288
    s_add_u32 s41, s47, 0xc0000
    buffer_load_dwordx4 v11, s[16:19], s41 offen  lds
    s_add_u32 m0, s45, 14336
    s_add_u32 s41, s47, 0xc1000
    buffer_load_dwordx4 v11, s[16:19], s41 offen  lds
    s_bfe_u32 s60, s46, 0x40014
    s_lshl_b32 s60, s60, 13
    s_add_u32 s60, s60, s49
    s_add_u32 m0, s45, 139264
    s_add_u32 s41, s60, 0x0
    buffer_load_dwordx4 v16, s[28:31], s41 offen sc1 lds
    s_add_u32 m0, s45, 141312
    s_add_u32 s41, s60, 0x800
    buffer_load_dwordx4 v16, s[28:31], s41 offen sc1 lds
    s_add_u32 m0, s45, 143360
    s_add_u32 s41, s60, 0x1000
    buffer_load_dwordx4 v16, s[28:31], s41 offen sc1 lds
    s_add_u32 m0, s45, 145408
    s_add_u32 s41, s60, 0x1800
    buffer_load_dwordx4 v16, s[28:31], s41 offen sc1 lds
    s_add_u32 m0, s45, 49152
    s_add_u32 s41, s48, 0x20000
    buffer_load_dwordx4 v14, s[24:27], s41 offen  lds
    s_add_u32 m0, s45, 51200
    s_add_u32 s41, s48, 0x24000
    buffer_load_dwordx4 v15, s[24:27], s41 offen  lds
    s_add_u32 m0, s45, 53248
    s_add_u32 s41, s48, 0x28000
    buffer_load_dwordx4 v14, s[24:27], s41 offen  lds
    s_add_u32 m0, s45, 55296
    s_add_u32 s41, s48, 0x2c000
    buffer_load_dwordx4 v15, s[24:27], s41 offen  lds
    s_waitcnt vmcnt(24)
    s_barrier
    s_add_u32 m0, s45, 57344
    s_add_u32 s41, s48, 0x30000
    buffer_load_dwordx4 v14, s[24:27], s41 offen  lds
    s_add_u32 m0, s45, 59392
    s_add_u32 s41, s48, 0x34000
    buffer_load_dwordx4 v15, s[24:27], s41 offen  lds
    s_add_u32 m0, s45, 61440
    s_add_u32 s41, s48, 0x38000
    buffer_load_dwordx4 v14, s[24:27], s41 offen  lds
    s_add_u32 m0, s45, 63488
    s_add_u32 s41, s48, 0x3c000
    buffer_load_dwordx4 v15, s[24:27], s41 offen  lds
    s_add_u32 m0, s45, 32768
    s_add_u32 s41, s47, 0x80
    buffer_load_dwordx4 v11, s[16:19], s41 offen  lds
    s_add_u32 m0, s45, 34816
    s_add_u32 s41, s47, 0x1080
    buffer_load_dwordx4 v11, s[16:19], s41 offen  lds
    s_add_u32 m0, s45, 36864
    s_add_u32 s41, s47, 0x40080
    buffer_load_dwordx4 v11, s[16:19], s41 offen  lds
    s_add_u32 m0, s45, 38912
    s_add_u32 s41, s47, 0x41080
    buffer_load_dwordx4 v11, s[16:19], s41 offen  lds
    s_add_u32 m0, s45, 40960
    s_add_u32 s41, s47, 0x80080
    buffer_load_dwordx4 v11, s[16:19], s41 offen  lds
    s_add_u32 m0, s45, 43008
    s_add_u32 s41, s47, 0x81080
    buffer_load_dwordx4 v11, s[16:19], s41 offen  lds
    s_add_u32 m0, s45, 45056
    s_add_u32 s41, s47, 0xc0080
    buffer_load_dwordx4 v11, s[16:19], s41 offen  lds
    s_add_u32 m0, s45, 47104
    s_add_u32 s41, s47, 0xc1080
    buffer_load_dwordx4 v11, s[16:19], s41 offen  lds
    s_bfe_u32 s54, s46, 0x4001c
    s_lshl_b32 s55, s54, 13
    s_add_u32 s47, s58, s55
    s_lshl_b32 s55, s54, 18
    s_add_u32 s48, s59, s55
    s_add_u32 m0, s45, 81920
    s_add_u32 s41, s48, 0x0
    buffer_load_dwordx4 v14, s[24:27], s41 offen  lds
    s_add_u32 m0, s45, 83968
    s_add_u32 s41, s48, 0x4000
    buffer_load_dwordx4 v15, s[24:27], s41 offen  lds
    s_add_u32 m0, s45, 86016
    s_add_u32 s41, s48, 0x8000
    buffer_load_dwordx4 v14, s[24:27], s41 offen  lds
    s_add_u32 m0, s45, 88064
    s_add_u32 s41, s48, 0xc000
    buffer_load_dwordx4 v15, s[24:27], s41 offen  lds
    s_waitcnt vmcnt(24)
    s_barrier
    s_add_u32 m0, s45, 90112
    s_add_u32 s41, s48, 0x10000
    buffer_load_dwordx4 v14, s[24:27], s41 offen  lds
    s_add_u32 m0, s45, 92160
    s_add_u32 s41, s48, 0x14000
    buffer_load_dwordx4 v15, s[24:27], s41 offen  lds
    s_add_u32 m0, s45, 94208
    s_add_u32 s41, s48, 0x18000
    buffer_load_dwordx4 v14, s[24:27], s41 offen  lds
    s_add_u32 m0, s45, 96256
    s_add_u32 s41, s48, 0x1c000
    buffer_load_dwordx4 v15, s[24:27], s41 offen  lds
    s_add_u32 m0, s45, 65536
    s_add_u32 s41, s47, 0x0
    buffer_load_dwordx4 v11, s[16:19], s41 offen  lds
    s_add_u32 m0, s45, 67584
    s_add_u32 s41, s47, 0x1000
    buffer_load_dwordx4 v11, s[16:19], s41 offen  lds
    s_add_u32 m0, s45, 69632
    s_add_u32 s41, s47, 0x40000
    buffer_load_dwordx4 v11, s[16:19], s41 offen  lds
    s_add_u32 m0, s45, 71680
    s_add_u32 s41, s47, 0x41000
    buffer_load_dwordx4 v11, s[16:19], s41 offen  lds
    s_add_u32 m0, s45, 73728
    s_add_u32 s41, s47, 0x80000
    buffer_load_dwordx4 v11, s[16:19], s41 offen  lds
    s_add_u32 m0, s45, 75776
    s_add_u32 s41, s47, 0x81000
    buffer_load_dwordx4 v11, s[16:19], s41 offen  lds
    s_add_u32 m0, s45, 77824
    s_add_u32 s41, s47, 0xc0000
    buffer_load_dwordx4 v11, s[16:19], s41 offen  lds
    s_add_u32 m0, s45, 79872
    s_add_u32 s41, s47, 0xc1000
    buffer_load_dwordx4 v11, s[16:19], s41 offen  lds
    s_bfe_u32 s60, s46, 0x40018
    s_lshl_b32 s60, s60, 13
    s_add_u32 s60, s60, s49
    s_add_u32 m0, s45, 147456
    s_add_u32 s41, s60, 0x0
    buffer_load_dwordx4 v16, s[28:31], s41 offen sc1 lds
    s_add_u32 m0, s45, 149504
    s_add_u32 s41, s60, 0x800
    buffer_load_dwordx4 v16, s[28:31], s41 offen sc1 lds
    s_add_u32 m0, s45, 151552
    s_add_u32 s41, s60, 0x1000
    buffer_load_dwordx4 v16, s[28:31], s41 offen sc1 lds
    s_add_u32 m0, s45, 153600
    s_add_u32 s41, s60, 0x1800
    buffer_load_dwordx4 v16, s[28:31], s41 offen sc1 lds
    s_bfe_u32 s60, s46, 0x4001c
    s_lshl_b32 s60, s60, 13
    s_add_u32 s60, s60, s49
    s_add_u32 m0, s45, 155648
    s_add_u32 s41, s60, 0x0
    buffer_load_dwordx4 v16, s[28:31], s41 offen sc1 lds
    s_add_u32 m0, s45, 157696
    s_add_u32 s41, s60, 0x800
    buffer_load_dwordx4 v16, s[28:31], s41 offen sc1 lds
    s_add_u32 m0, s45, 159744
    s_add_u32 s41, s60, 0x1000
    buffer_load_dwordx4 v16, s[28:31], s41 offen sc1 lds
    s_add_u32 m0, s45, 161792
    s_add_u32 s41, s60, 0x1800
    buffer_load_dwordx4 v16, s[28:31], s41 offen sc1 lds
    s_add_u32 m0, s45, 114688
    s_add_u32 s41, s48, 0x20000
    buffer_load_dwordx4 v14, s[24:27], s41 offen  lds
    s_add_u32 m0, s45, 116736
    s_add_u32 s41, s48, 0x24000
    buffer_load_dwordx4 v15, s[24:27], s41 offen  lds
    s_add_u32 m0, s45, 118784
    s_add_u32 s41, s48, 0x28000
    buffer_load_dwordx4 v14, s[24:27], s41 offen  lds
    s_add_u32 m0, s45, 120832
    s_add_u32 s41, s48, 0x2c000
    buffer_load_dwordx4 v15, s[24:27], s41 offen  lds
    s_waitcnt vmcnt(28)
    s_barrier
    s_add_u32 m0, s45, 122880
    s_add_u32 s41, s48, 0x30000
    buffer_load_dwordx4 v14, s[24:27], s41 offen  lds
    s_add_u32 m0, s45, 124928
    s_add_u32 s41, s48, 0x34000
    buffer_load_dwordx4 v15, s[24:27], s41 offen  lds
    s_add_u32 m0, s45, 126976
    s_add_u32 s41, s48, 0x38000
    buffer_load_dwordx4 v14, s[24:27], s41 offen  lds
    s_add_u32 m0, s45, 129024
    s_add_u32 s41, s48, 0x3c000
    buffer_load_dwordx4 v15, s[24:27], s41 offen  lds
    s_add_u32 m0, s45, 98304
    s_add_u32 s41, s47, 0x80
    buffer_load_dwordx4 v11, s[16:19], s41 offen  lds
    s_add_u32 m0, s45, 100352
    s_add_u32 s41, s47, 0x1080
    buffer_load_dwordx4 v11, s[16:19], s41 offen  lds
    s_add_u32 m0, s45, 102400
    s_add_u32 s41, s47, 0x40080
    buffer_load_dwordx4 v11, s[16:19], s41 offen  lds
    s_add_u32 m0, s45, 104448
    s_add_u32 s41, s47, 0x41080
    buffer_load_dwordx4 v11, s[16:19], s41 offen  lds
    s_add_u32 m0, s45, 106496
    s_add_u32 s41, s47, 0x80080
    buffer_load_dwordx4 v11, s[16:19], s41 offen  lds
    s_add_u32 m0, s45, 108544
    s_add_u32 s41, s47, 0x81080
    buffer_load_dwordx4 v11, s[16:19], s41 offen  lds
    s_add_u32 m0, s45, 110592
    s_add_u32 s41, s47, 0xc0080
    buffer_load_dwordx4 v11, s[16:19], s41 offen  lds
    s_add_u32 m0, s45, 112640
    s_add_u32 s41, s47, 0xc1080
    buffer_load_dwordx4 v11, s[16:19], s41 offen  lds
    s_waitcnt vmcnt(24)
    s_barrier
    s_waitcnt vmcnt(0)
    s_barrier
    s_endpgm
L_other:
    s_mov_b32 s30, 0x1400000
    s_mov_b32 s31, 0x20000
    s_lshl_b32 s38, s3, 2
    s_add_u32 s38, s38, s5
    s_lshl_b32 s61, s38, 2
    s_add_u32 s61, s61, s4
    s_cmp_lt_u32 s7, 4
    s_cbranch_scc1 L_compute
    s_cmp_eq_u32 s7, 6
    s_cbranch_scc1 L_end
    s_waitcnt lgkmcnt(0)
    s_lshl_b32 s40, s38, 7
    s_load_dwordx2 s[36:37], s[28:29], s40
    v_bfe_u32 v1, v0, 2, 3
    v_and_b32 v2, 3, v0
    v_lshlrev_b32 v2, 3, v2
    v_lshl_add_u32 v4, v1, 7, v2
    s_lshl_b32 s43, s61, 10
    s_add_u32 s43, s43, 0x4000
    s_waitcnt lgkmcnt(0)
    s_mul_i32 s36, s36, 0x9e3779b1
    s_add_u32 s36, s36, 0x7f4a7c15
    s_mul_i32 s37, s37, 0x85ebca6b
    s_add_u32 s37, s37, 0xc2b2ae35
    v_mov_b32 v2, s36
    v_mov_b32 v3, s37
    s_mov_b32 s44, 21
L_pb:
    s_barrier
    s_sub_u32 s44, s44, 1
    s_cmp_lg_u32 s44, 0
    s_cbranch_scc1 L_pb
    s_mov_b32 s44, 100000
L_ppoll:
    buffer_load_dwordx2 v[8:9], v4, s[28:31], s43 offen sc1
    s_sub_u32 s44, s44, 1
    s_cmp_eq_u32 s44, 0
    s_waitcnt vmcnt(0)
    s_cbranch_scc1 L_end
    v_cmp_ne_u64 vcc, v[8:9], v[2:3]
    s_cbranch_vccz L_end
    s_sleep 2
    s_branch L_ppoll
L_end:
    s_endpgm
L_compute:
    s_load_dwordx2 s[32:33], s[0:1], 80
    s_mov_b32 s34, 0x200000
    s_mov_b32 s35, 0x20000
    s_lshr_b32 s56, s7, 1
    s_and_b32 s57, s7, 1
    v_and_b32 v1, 15, v0
    v_lshrrev_b32 v2, 4, v0
    v_lshrrev_b32 v3, 1, v1
    v_xor_b32 v4, v3, v2
    v_lshlrev_b32 v4, 4, v4
    v_lshl_add_u32 v4, v1, 7, v4
    s_lshl_b32 s43, s7, 12
    s_xor_b32 s42, s43, 4096
    v_add_u32 v8, s42, v4
    v_add_u32 v9, s43, v4
    v_xor_b32 v10, 64, v8
    v_xor_b32 v11, 64, v9
    v_lshrrev_b32 v5, 1, v2
    v_xor_b32 v5, v5, v3
    v_lshlrev_b32 v5, 4, v5
    v_lshl_add_u32 v5, v1, 7, v5
    v_and_b32 v6, 1, v2
    v_lshl_add_u32 v5, v6, 3, v5
    s_lshl_b32 s44, s57, 14
    s_add_u32 s44, s44, 131072
    s_add_u32 s42, s42, s44
    s_add_u32 s43, s43, s44
    v_add_u32 v115, s42, v5
    v_add_u32 v116, s43, v5
    v_xor_b32 v119, 32, v115
    v_xor_b32 v120, 64, v115
    v_xor_b32 v121, 96, v115
    v_xor_b32 v122, 32, v116
    v_xor_b32 v123, 64, v116
    v_xor_b32 v124, 96, v116
    v_bfe_u32 v5, v0, 2, 2
    v_lshl_add_u32 v4, v2, 3, v5
    v_lshlrev_b32 v4, 8, v4
    v_and_b32 v3, 3, v0
    v_lshl_add_u32 v4, v3, 3, v4
    v_add_u32 v4, 16384, v4
    v_lshlrev_b32 v5, 1, v5
    v_or_b32 v5, v5, v6
    s_lshl_b32 s40, s57, 2
    s_add_u32 s41, s40, 0
    v_xor_b32 v3, s41, v5
    v_lshl_add_u32 v12, v3, 5, v4
    s_add_u32 s41, s40, 1
    v_xor_b32 v3, s41, v5
    v_lshl_add_u32 v13, v3, 5, v4
    s_add_u32 s41, s40, 2
    v_xor_b32 v3, s41, v5
    v_lshl_add_u32 v14, v3, 5, v4
    s_add_u32 s41, s40, 3
    v_xor_b32 v3, s41, v5
    v_lshl_add_u32 v15, v3, 5, v4
    s_lshr_b32 s52, s4, 1
    s_lshl_b32 s52, s52, 12
    s_lshl_b32 s53, s4, 10
    s_add_u32 s53, s53, 131072
    v_lshlrev_b32 v7, 4, v0
    v_mov_b32 v114, 0
    s_mov_b32 s50, 0x3e0293ee
    s_lshl_b32 s40, s56, 13
    s_add_u32 s40, s40, s44
    v_add_u32 v125, s40, v7
    v_xor_b32 v126, 0x4000, v125
    s_lshl_b32 s41, s7, 11
    s_xor_b32 s42, s41, 2048
    v_add_u32 v117, s42, v7
    v_add_u32 v118, s41, v7
    v_add_u32 v127, 131072, v118
    s_waitcnt lgkmcnt(0)
    s_lshl_b32 s40, s38, 7
    s_load_dwordx2 s[36:37], s[28:29], s40
    s_lshl_b32 s40, s61, 3
    s_add_u32 s40, s40, s39
    s_lshl_b32 s49, s40, 13
    s_add_u32 s49, s49, 0x100000
    s_lshl_b32 s40, s40, 7
    s_lshl_b32 s41, s7, 3
    s_add_u32 s40, s40, s41
    s_add_u32 s60, s40, 0x4000
    s_waitcnt lgkmcnt(0)
    s_mul_i32 s36, s36, 0x9e3779b1
    s_add_u32 s36, s36, 0x7f4a7c15
    s_mul_i32 s37, s37, 0x85ebca6b
    s_add_u32 s37, s37, 0xc2b2ae35
    v_mov_b32 v112, s36
    v_mov_b32 v113, s37
    s_barrier
    ds_read_b64_tr_b16 v[32:33], v12 offset:0
    ds_read_b64_tr_b16 v[34:35], v12 offset:1024
    ds_read_b64_tr_b16 v[36:37], v13 offset:0
    ds_read_b128 v[16:19], v8 offset:0
    ds_read_b64_tr_b16 v[38:39], v13 offset:1024
    ds_read_b64_tr_b16 v[40:41], v14 offset:0
    ds_read_b64_tr_b16 v[42:43], v14 offset:1024
    ds_read_b128 v[20:23], v8 offset:2048
    ds_read_b64_tr_b16 v[44:45], v15 offset:0
    ds_read_b64_tr_b16 v[46:47], v15 offset:1024
    ds_read_b128 v[24:27], v9 offset:0
    ds_read_b128 v[28:31], v9 offset:2048
    s_waitcnt lgkmcnt(8)
    v_mfma_f32_16x16x32_bf16 v[128:131], v[32:35], v[16:19], 0
    ds_read_b64_tr_b16 v[48:49], v12 offset:8192
    s_waitcnt lgkmcnt(8)
    v_mfma_f32_16x16x32_bf16 v[132:135], v[36:39], v[16:19], 0
    ds_read_b64_tr_b16 v[50:51], v12 offset:9216
    s_waitcnt lgkmcnt(7)
    v_mfma_f32_16x16x32_bf16 v[136:139], v[40:43], v[16:19], 0
    ds_read_b64_tr_b16 v[52:53], v13 offset:8192
    s_waitcnt lgkmcnt(5)
    v_mfma_f32_16x16x32_bf16 v[140:143], v[44:47], v[16:19], 0
    ds_read_b128 v[16:19], v10 offset:0
    v_mfma_f32_16x16x32_bf16 v[144:147], v[32:35], v[20:23], 0
    ds_read_b64_tr_b16 v[54:55], v13 offset:9216
    v_mfma_f32_16x16x32_bf16 v[148:151], v[36:39], v[20:23], 0
    ds_read_b64_tr_b16 v[56:57], v14 offset:8192
    v_mfma_f32_16x16x32_bf16 v[152:155], v[40:43], v[20:23], 0
    ds_read_b64_tr_b16 v[58:59], v14 offset:9216
    v_mfma_f32_16x16x32_bf16 v[156:159], v[44:47], v[20:23], 0
    ds_read_b128 v[20:23], v10 offset:2048
    s_waitcnt lgkmcnt(9)
    v_mfma_f32_16x16x32_bf16 v[160:163], v[32:35], v[24:27], 0
    ds_read_b64_tr_b16 v[60:61], v15 offset:8192
    v_mfma_f32_16x16x32_bf16 v[164:167], v[36:39], v[24:27], 0
    ds_read_b64_tr_b16 v[62:63], v15 offset:9216
    v_mfma_f32_16x16x32_bf16 v[168:171], v[40:43], v[24:27], 0
    v_mfma_f32_16x16x32_bf16 v[172:175], v[44:47], v[24:27], 0
    ds_read_b128 v[24:27], v11 offset:0
    s_waitcnt lgkmcnt(11)
    v_mfma_f32_16x16x32_bf16 v[176:179], v[32:35], v[28:31], 0
    v_mfma_f32_16x16x32_bf16 v[180:183], v[36:39], v[28:31], 0
    v_mfma_f32_16x16x32_bf16 v[184:187], v[40:43], v[28:31], 0
    v_mfma_f32_16x16x32_bf16 v[188:191], v[44:47], v[28:31], 0
    ds_read_b128 v[28:31], v11 offset:2048
    s_waitcnt lgkmcnt(8)
    v_mfma_f32_16x16x32_bf16 v[128:131], v[48:51], v[16:19], v[128:131]
    s_waitcnt lgkmcnt(7)
    v_mfma_f32_16x16x32_bf16 v[132:135], v[52:55], v[16:19], v[132:135]
    s_waitcnt lgkmcnt(5)
    v_mfma_f32_16x16x32_bf16 v[136:139], v[56:59], v[16:19], v[136:139]
    s_waitcnt lgkmcnt(2)
    v_mfma_f32_16x16x32_bf16 v[140:143], v[60:63], v[16:19], v[140:143]
    s_waitcnt lgkmcnt(0)
    s_barrier
    ds_read_b128 v[16:19], v8 offset:32768
    v_mfma_f32_16x16x32_bf16 v[144:147], v[48:51], v[20:23], v[144:147]
    ds_read_b64_tr_b16 v[32:33], v12 offset:32768
    v_mfma_f32_16x16x32_bf16 v[148:151], v[52:55], v[20:23], v[148:151]
    ds_read_b64_tr_b16 v[34:35], v12 offset:33792
    v_mfma_f32_16x16x32_bf16 v[152:155], v[56:59], v[20:23], v[152:155]
    ds_read_b64_tr_b16 v[36:37], v13 offset:32768
    v_mfma_f32_16x16x32_bf16 v[156:159], v[60:63], v[20:23], v[156:159]
    ds_read_b128 v[20:23], v8 offset:34816
    v_mfma_f32_16x16x32_bf16 v[160:163], v[48:51], v[24:27], v[160:163]
    ds_read_b64_tr_b16 v[38:39], v13 offset:33792
    v_mfma_f32_16x16x32_bf16 v[164:167], v[52:55], v[24:27], v[164:167]
    ds_read_b64_tr_b16 v[40:41], v14 offset:32768
    v_mfma_f32_16x16x32_bf16 v[168:171], v[56:59], v[24:27], v[168:171]
    ds_read_b64_tr_b16 v[42:43], v14 offset:33792
    v_mfma_f32_16x16x32_bf16 v[172:175], v[60:63], v[24:27], v[172:175]
    ds_read_b128 v[24:27], v9 offset:32768
    v_mfma_f32_16x16x32_bf16 v[176:179], v[48:51], v[28:31], v[176:179]
    ds_read_b64_tr_b16 v[44:45], v15 offset:32768
    v_mfma_f32_16x16x32_bf16 v[180:183], v[52:55], v[28:31], v[180:183]
    ds_read_b64_tr_b16 v[46:47], v15 offset:33792
    v_mfma_f32_16x16x32_bf16 v[184:187], v[56:59], v[28:31], v[184:187]
    v_mfma_f32_16x16x32_bf16 v[188:191], v[60:63], v[28:31], v[188:191]
    ds_read_b128 v[28:31], v9 offset:34816
    s_waitcnt lgkmcnt(9)
    v_mfma_f32_16x16x32_bf16 v[128:131], v[32:35], v[16:19], v[128:131]
    ds_read_b64_tr_b16 v[48:49], v12 offset:40960
    s_waitcnt lgkmcnt(7)
    v_mfma_f32_16x16x32_bf16 v[132:135], v[36:39], v[16:19], v[132:135]
    ds_read_b64_tr_b16 v[50:51], v12 offset:41984
    s_waitcnt lgkmcnt(6)
    v_mfma_f32_16x16x32_bf16 v[136:139], v[40:43], v[16:19], v[136:139]
    ds_read_b64_tr_b16 v[52:53], v13 offset:40960
    s_waitcnt lgkmcnt(4)
    v_mfma_f32_16x16x32_bf16 v[140:143], v[44:47], v[16:19], v[140:143]
    ds_read_b128 v[16:19], v10 offset:32768
    v_mfma_f32_16x16x32_bf16 v[144:147], v[32:35], v[20:23], v[144:147]
    ds_read_b64_tr_b16 v[54:55], v13 offset:41984
    v_mfma_f32_16x16x32_bf16 v[148:151], v[36:39], v[20:23], v[148:151]
    ds_read_b64_tr_b16 v[56:57], v14 offset:40960
    v_mfma_f32_16x16x32_bf16 v[152:155], v[40:43], v[20:23], v[152:155]
    ds_read_b64_tr_b16 v[58:59], v14 offset:41984
    v_mfma_f32_16x16x32_bf16 v[156:159], v[44:47], v[20:23], v[156:159]
    ds_read_b128 v[20:23], v10 offset:34816
    v_mfma_f32_16x16x32_bf16 v[160:163], v[32:35], v[24:27], v[160:163]
    ds_read_b64_tr_b16 v[60:61], v15 offset:40960
    v_mfma_f32_16x16x32_bf16 v[164:167], v[36:39], v[24:27], v[164:167]
    ds_read_b64_tr_b16 v[62:63], v15 offset:41984
    v_mfma_f32_16x16x32_bf16 v[168:171], v[40:43], v[24:27], v[168:171]
    v_add_u32 v8, 0x10000, v8
    v_add_u32 v9, 0x10000, v9
    v_mfma_f32_16x16x32_bf16 v[172:175], v[44:47], v[24:27], v[172:175]
    ds_read_b128 v[24:27], v11 offset:32768
    s_waitcnt lgkmcnt(11)
    v_mfma_f32_16x16x32_bf16 v[176:179], v[32:35], v[28:31], v[176:179]
    v_add_u32 v12, 0x10000, v12
    v_mfma_f32_16x16x32_bf16 v[180:183], v[36:39], v[28:31], v[180:183]
    v_add_u32 v13, 0x10000, v13
    v_mfma_f32_16x16x32_bf16 v[184:187], v[40:43], v[28:31], v[184:187]
    v_add_u32 v14, 0x10000, v14
    v_add_u32 v15, 0x10000, v15
    v_mfma_f32_16x16x32_bf16 v[188:191], v[44:47], v[28:31], v[188:191]
    ds_read_b128 v[28:31], v11 offset:34816
    s_waitcnt lgkmcnt(8)
    v_mfma_f32_16x16x32_bf16 v[128:131], v[48:51], v[16:19], v[128:131]
    v_add_u32 v10, 0x10000, v10
    s_waitcnt lgkmcnt(7)
    v_mfma_f32_16x16x32_bf16 v[132:135], v[52:55], v[16:19], v[132:135]
    v_add_u32 v11, 0x10000, v11
    s_waitcnt lgkmcnt(5)
    v_mfma_f32_16x16x32_bf16 v[136:139], v[56:59], v[16:19], v[136:139]
    s_waitcnt lgkmcnt(2)
    v_mfma_f32_16x16x32_bf16 v[140:143], v[60:63], v[16:19], v[140:143]
    s_waitcnt lgkmcnt(0)
    s_barrier
    ds_read_b128 v[16:19], v8 offset:0
    v_mfma_f32_16x16x32_bf16 v[144:147], v[48:51], v[20:23], v[144:147]
    ds_read_b64_tr_b16 v[32:33], v12 offset:0
    v_mfma_f32_16x16x32_bf16 v[148:151], v[52:55], v[20:23], v[148:151]
    ds_read_b64_tr_b16 v[34:35], v12 offset:1024
    v_mfma_f32_16x16x32_bf16 v[152:155], v[56:59], v[20:23], v[152:155]
    ds_read_b64_tr_b16 v[36:37], v13 offset:0
    v_mfma_f32_16x16x32_bf16 v[156:159], v[60:63], v[20:23], v[156:159]
    ds_read_b128 v[20:23], v8 offset:2048
    v_mfma_f32_16x16x32_bf16 v[160:163], v[48:51], v[24:27], v[160:163]
    ds_read_b64_tr_b16 v[38:39], v13 offset:1024
    v_mfma_f32_16x16x32_bf16 v[164:167], v[52:55], v[24:27], v[164:167]
    ds_read_b64_tr_b16 v[40:41], v14 offset:0
    v_mfma_f32_16x16x32_bf16 v[168:171], v[56:59], v[24:27], v[168:171]
    ds_read_b64_tr_b16 v[42:43], v14 offset:1024
    v_mfma_f32_16x16x32_bf16 v[172:175], v[60:63], v[24:27], v[172:175]
    ds_read_b128 v[24:27], v9 offset:0
    v_mfma_f32_16x16x32_bf16 v[176:179], v[48:51], v[28:31], v[176:179]
    ds_read_b64_tr_b16 v[44:45], v15 offset:0
    v_mfma_f32_16x16x32_bf16 v[180:183], v[52:55], v[28:31], v[180:183]
    ds_read_b64_tr_b16 v[46:47], v15 offset:1024
    v_mfma_f32_16x16x32_bf16 v[184:187], v[56:59], v[28:31], v[184:187]
    v_mfma_f32_16x16x32_bf16 v[188:191], v[60:63], v[28:31], v[188:191]
    ds_read_b128 v[28:31], v9 offset:2048
    s_waitcnt lgkmcnt(9)
    v_mfma_f32_16x16x32_bf16 v[128:131], v[32:35], v[16:19], v[128:131]
    ds_read_b64_tr_b16 v[48:49], v12 offset:8192
    s_waitcnt lgkmcnt(7)
    v_mfma_f32_16x16x32_bf16 v[132:135], v[36:39], v[16:19], v[132:135]
    ds_read_b64_tr_b16 v[50:51], v12 offset:9216
    s_waitcnt lgkmcnt(6)
    v_mfma_f32_16x16x32_bf16 v[136:139], v[40:43], v[16:19], v[136:139]
    ds_read_b64_tr_b16 v[52:53], v13 offset:8192
    s_waitcnt lgkmcnt(4)
    v_mfma_f32_16x16x32_bf16 v[140:143], v[44:47], v[16:19], v[140:143]
    ds_read_b128 v[16:19], v10 offset:0
    v_mfma_f32_16x16x32_bf16 v[144:147], v[32:35], v[20:23], v[144:147]
    ds_read_b64_tr_b16 v[54:55], v13 offset:9216
    v_mfma_f32_16x16x32_bf16 v[148:151], v[36:39], v[20:23], v[148:151]
    ds_read_b64_tr_b16 v[56:57], v14 offset:8192
    v_mfma_f32_16x16x32_bf16 v[152:155], v[40:43], v[20:23], v[152:155]
    ds_read_b64_tr_b16 v[58:59], v14 offset:9216
    v_mfma_f32_16x16x32_bf16 v[156:159], v[44:47], v[20:23], v[156:159]
    ds_read_b128 v[20:23], v10 offset:2048
    v_mfma_f32_16x16x32_bf16 v[160:163], v[32:35], v[24:27], v[160:163]
    ds_read_b64_tr_b16 v[60:61], v15 offset:8192
    v_mfma_f32_16x16x32_bf16 v[164:167], v[36:39], v[24:27], v[164:167]
    ds_read_b64_tr_b16 v[62:63], v15 offset:9216
    v_mfma_f32_16x16x32_bf16 v[168:171], v[40:43], v[24:27], v[168:171]
    v_mfma_f32_16x16x32_bf16 v[172:175], v[44:47], v[24:27], v[172:175]
    ds_read_b128 v[24:27], v11 offset:0
    s_waitcnt lgkmcnt(11)
    v_mfma_f32_16x16x32_bf16 v[176:179], v[32:35], v[28:31], v[176:179]
    v_mfma_f32_16x16x32_bf16 v[180:183], v[36:39], v[28:31], v[180:183]
    v_mfma_f32_16x16x32_bf16 v[184:187], v[40:43], v[28:31], v[184:187]
    v_mfma_f32_16x16x32_bf16 v[188:191], v[44:47], v[28:31], v[188:191]
    ds_read_b128 v[28:31], v11 offset:2048
    s_waitcnt lgkmcnt(8)
    v_mfma_f32_16x16x32_bf16 v[128:131], v[48:51], v[16:19], v[128:131]
    s_waitcnt lgkmcnt(7)
    v_mfma_f32_16x16x32_bf16 v[132:135], v[52:55], v[16:19], v[132:135]
    s_waitcnt lgkmcnt(5)
    v_mfma_f32_16x16x32_bf16 v[136:139], v[56:59], v[16:19], v[136:139]
    s_waitcnt lgkmcnt(2)
    v_mfma_f32_16x16x32_bf16 v[140:143], v[60:63], v[16:19], v[140:143]
    s_waitcnt lgkmcnt(0)
    s_barrier
    ds_read_b128 v[16:19], v8 offset:32768
    v_mfma_f32_16x16x32_bf16 v[144:147], v[48:51], v[20:23], v[144:147]
    ds_read_b64_tr_b16 v[32:33], v12 offset:32768
    v_mfma_f32_16x16x32_bf16 v[148:151], v[52:55], v[20:23], v[148:151]
    ds_read_b64_tr_b16 v[34:35], v12 offset:33792
    v_mfma_f32_16x16x32_bf16 v[152:155], v[56:59], v[20:23], v[152:155]
    ds_read_b64_tr_b16 v[36:37], v13 offset:32768
    v_mfma_f32_16x16x32_bf16 v[156:159], v[60:63], v[20:23], v[156:159]
    ds_read_b128 v[20:23], v8 offset:34816
    v_mfma_f32_16x16x32_bf16 v[160:163], v[48:51], v[24:27], v[160:163]
    ds_read_b64_tr_b16 v[38:39], v13 offset:33792
    v_mfma_f32_16x16x32_bf16 v[164:167], v[52:55], v[24:27], v[164:167]
    ds_read_b64_tr_b16 v[40:41], v14 offset:32768
    v_mfma_f32_16x16x32_bf16 v[168:171], v[56:59], v[24:27], v[168:171]
    ds_read_b64_tr_b16 v[42:43], v14 offset:33792
    v_mfma_f32_16x16x32_bf16 v[172:175], v[60:63], v[24:27], v[172:175]
    ds_read_b128 v[24:27], v9 offset:32768
    v_mfma_f32_16x16x32_bf16 v[176:179], v[48:51], v[28:31], v[176:179]
    ds_read_b64_tr_b16 v[44:45], v15 offset:32768
    v_mfma_f32_16x16x32_bf16 v[180:183], v[52:55], v[28:31], v[180:183]
    ds_read_b64_tr_b16 v[46:47], v15 offset:33792
    v_mfma_f32_16x16x32_bf16 v[184:187], v[56:59], v[28:31], v[184:187]
    v_mfma_f32_16x16x32_bf16 v[188:191], v[60:63], v[28:31], v[188:191]
    ds_read_b128 v[28:31], v9 offset:34816
    s_waitcnt lgkmcnt(9)
    v_mfma_f32_16x16x32_bf16 v[128:131], v[32:35], v[16:19], v[128:131]
    ds_read_b64_tr_b16 v[48:49], v12 offset:40960
    s_waitcnt lgkmcnt(7)
    v_mfma_f32_16x16x32_bf16 v[132:135], v[36:39], v[16:19], v[132:135]
    ds_read_b64_tr_b16 v[50:51], v12 offset:41984
    s_waitcnt lgkmcnt(6)
    v_mfma_f32_16x16x32_bf16 v[136:139], v[40:43], v[16:19], v[136:139]
    ds_read_b64_tr_b16 v[52:53], v13 offset:40960
    s_waitcnt lgkmcnt(4)
    v_mfma_f32_16x16x32_bf16 v[140:143], v[44:47], v[16:19], v[140:143]
    ds_read_b128 v[16:19], v10 offset:32768
    v_mfma_f32_16x16x32_bf16 v[144:147], v[32:35], v[20:23], v[144:147]
    ds_read_b64_tr_b16 v[54:55], v13 offset:41984
    v_mfma_f32_16x16x32_bf16 v[148:151], v[36:39], v[20:23], v[148:151]
    ds_read_b64_tr_b16 v[56:57], v14 offset:40960
    v_mfma_f32_16x16x32_bf16 v[152:155], v[40:43], v[20:23], v[152:155]
    ds_read_b64_tr_b16 v[58:59], v14 offset:41984
    v_mfma_f32_16x16x32_bf16 v[156:159], v[44:47], v[20:23], v[156:159]
    ds_read_b128 v[20:23], v10 offset:34816
    v_mfma_f32_16x16x32_bf16 v[160:163], v[32:35], v[24:27], v[160:163]
    ds_read_b64_tr_b16 v[60:61], v15 offset:40960
    v_mfma_f32_16x16x32_bf16 v[164:167], v[36:39], v[24:27], v[164:167]
    ds_read_b64_tr_b16 v[62:63], v15 offset:41984
    v_mfma_f32_16x16x32_bf16 v[168:171], v[40:43], v[24:27], v[168:171]
    v_add_u32 v8, 0xffff0000, v8
    v_add_u32 v9, 0xffff0000, v9
    v_mfma_f32_16x16x32_bf16 v[172:175], v[44:47], v[24:27], v[172:175]
    ds_read_b128 v[24:27], v11 offset:32768
    s_waitcnt lgkmcnt(11)
    v_mfma_f32_16x16x32_bf16 v[176:179], v[32:35], v[28:31], v[176:179]
    v_add_u32 v12, 0xffff0000, v12
    v_mfma_f32_16x16x32_bf16 v[180:183], v[36:39], v[28:31], v[180:183]
    v_add_u32 v13, 0xffff0000, v13
    v_mfma_f32_16x16x32_bf16 v[184:187], v[40:43], v[28:31], v[184:187]
    v_add_u32 v14, 0xffff0000, v14
    v_add_u32 v15, 0xffff0000, v15
    v_mfma_f32_16x16x32_bf16 v[188:191], v[44:47], v[28:31], v[188:191]
    ds_read_b128 v[28:31], v11 offset:34816
    s_waitcnt lgkmcnt(8)
    v_mfma_f32_16x16x32_bf16 v[128:131], v[48:51], v[16:19], v[128:131]
    v_add_u32 v10, 0xffff0000, v10
    s_waitcnt lgkmcnt(7)
    v_mfma_f32_16x16x32_bf16 v[132:135], v[52:55], v[16:19], v[132:135]
    v_add_u32 v11, 0xffff0000, v11
    s_waitcnt lgkmcnt(5)
    v_mfma_f32_16x16x32_bf16 v[136:139], v[56:59], v[16:19], v[136:139]
    s_waitcnt lgkmcnt(2)
    v_mfma_f32_16x16x32_bf16 v[140:143], v[60:63], v[16:19], v[140:143]
    s_waitcnt lgkmcnt(0)
    s_barrier
    ds_read_b128 v[16:19], v8 offset:0
    v_mfma_f32_16x16x32_bf16 v[144:147], v[48:51], v[20:23], v[144:147]
    ds_read_b64_tr_b16 v[32:33], v12 offset:0
    v_mfma_f32_16x16x32_bf16 v[148:151], v[52:55], v[20:23], v[148:151]
    ds_read_b64_tr_b16 v[34:35], v12 offset:1024
    v_mfma_f32_16x16x32_bf16 v[152:155], v[56:59], v[20:23], v[152:155]
    ds_read_b64_tr_b16 v[36:37], v13 offset:0
    v_mfma_f32_16x16x32_bf16 v[156:159], v[60:63], v[20:23], v[156:159]
    ds_read_b128 v[20:23], v8 offset:2048
    v_mfma_f32_16x16x32_bf16 v[160:163], v[48:51], v[24:27], v[160:163]
    ds_read_b64_tr_b16 v[38:39], v13 offset:1024
    v_mfma_f32_16x16x32_bf16 v[164:167], v[52:55], v[24:27], v[164:167]
    ds_read_b64_tr_b16 v[40:41], v14 offset:0
    v_mfma_f32_16x16x32_bf16 v[168:171], v[56:59], v[24:27], v[168:171]
    ds_read_b64_tr_b16 v[42:43], v14 offset:1024
    v_mfma_f32_16x16x32_bf16 v[172:175], v[60:63], v[24:27], v[172:175]
    ds_read_b128 v[24:27], v9 offset:0
    v_mfma_f32_16x16x32_bf16 v[176:179], v[48:51], v[28:31], v[176:179]
    ds_read_b64_tr_b16 v[44:45], v15 offset:0
    v_mfma_f32_16x16x32_bf16 v[180:183], v[52:55], v[28:31], v[180:183]
    ds_read_b64_tr_b16 v[46:47], v15 offset:1024
    v_mfma_f32_16x16x32_bf16 v[184:187], v[56:59], v[28:31], v[184:187]
    v_mfma_f32_16x16x32_bf16 v[188:191], v[60:63], v[28:31], v[188:191]
    ds_read_b128 v[28:31], v9 offset:2048
    s_waitcnt lgkmcnt(9)
    v_mfma_f32_16x16x32_bf16 v[128:131], v[32:35], v[16:19], v[128:131]
    ds_read_b64_tr_b16 v[48:49], v12 offset:8192
    s_waitcnt lgkmcnt(7)
    v_mfma_f32_16x16x32_bf16 v[132:135], v[36:39], v[16:19], v[132:135]
    ds_read_b64_tr_b16 v[50:51], v12 offset:9216
    s_waitcnt lgkmcnt(6)
    v_mfma_f32_16x16x32_bf16 v[136:139], v[40:43], v[16:19], v[136:139]
    ds_read_b64_tr_b16 v[52:53], v13 offset:8192
    s_waitcnt lgkmcnt(4)
    v_mfma_f32_16x16x32_bf16 v[140:143], v[44:47], v[16:19], v[140:143]
    ds_read_b128 v[16:19], v10 offset:0
    v_mfma_f32_16x16x32_bf16 v[144:147], v[32:35], v[20:23], v[144:147]
    ds_read_b64_tr_b16 v[54:55], v13 offset:9216
    v_mfma_f32_16x16x32_bf16 v[148:151], v[36:39], v[20:23], v[148:151]
    ds_read_b64_tr_b16 v[56:57], v14 offset:8192
    v_mfma_f32_16x16x32_bf16 v[152:155], v[40:43], v[20:23], v[152:155]
    ds_read_b64_tr_b16 v[58:59], v14 offset:9216
    v_mfma_f32_16x16x32_bf16 v[156:159], v[44:47], v[20:23], v[156:159]
    ds_read_b128 v[20:23], v10 offset:2048
    v_mfma_f32_16x16x32_bf16 v[160:163], v[32:35], v[24:27], v[160:163]
    ds_read_b64_tr_b16 v[60:61], v15 offset:8192
    v_mfma_f32_16x16x32_bf16 v[164:167], v[36:39], v[24:27], v[164:167]
    ds_read_b64_tr_b16 v[62:63], v15 offset:9216
    v_mfma_f32_16x16x32_bf16 v[168:171], v[40:43], v[24:27], v[168:171]
    v_mfma_f32_16x16x32_bf16 v[172:175], v[44:47], v[24:27], v[172:175]
    ds_read_b128 v[24:27], v11 offset:0
    s_waitcnt lgkmcnt(11)
    v_mfma_f32_16x16x32_bf16 v[176:179], v[32:35], v[28:31], v[176:179]
    v_mfma_f32_16x16x32_bf16 v[180:183], v[36:39], v[28:31], v[180:183]
    v_mfma_f32_16x16x32_bf16 v[184:187], v[40:43], v[28:31], v[184:187]
    v_mfma_f32_16x16x32_bf16 v[188:191], v[44:47], v[28:31], v[188:191]
    ds_read_b128 v[28:31], v11 offset:2048
    s_waitcnt lgkmcnt(8)
    v_mfma_f32_16x16x32_bf16 v[128:131], v[48:51], v[16:19], v[128:131]
    s_waitcnt lgkmcnt(7)
    v_mfma_f32_16x16x32_bf16 v[132:135], v[52:55], v[16:19], v[132:135]
    s_waitcnt lgkmcnt(5)
    v_mfma_f32_16x16x32_bf16 v[136:139], v[56:59], v[16:19], v[136:139]
    s_waitcnt lgkmcnt(2)
    v_mfma_f32_16x16x32_bf16 v[140:143], v[60:63], v[16:19], v[140:143]
    s_waitcnt lgkmcnt(0)
    s_barrier
    ds_read_b128 v[16:19], v8 offset:32768
    v_mfma_f32_16x16x32_bf16 v[144:147], v[48:51], v[20:23], v[144:147]
    ds_read_b64_tr_b16 v[32:33], v12 offset:32768
    v_mfma_f32_16x16x32_bf16 v[148:151], v[52:55], v[20:23], v[148:151]
    ds_read_b64_tr_b16 v[34:35], v12 offset:33792
    v_mfma_f32_16x16x32_bf16 v[152:155], v[56:59], v[20:23], v[152:155]
    ds_read_b64_tr_b16 v[36:37], v13 offset:32768
    v_mfma_f32_16x16x32_bf16 v[156:159], v[60:63], v[20:23], v[156:159]
    ds_read_b128 v[20:23], v8 offset:34816
    v_mfma_f32_16x16x32_bf16 v[160:163], v[48:51], v[24:27], v[160:163]
    ds_read_b64_tr_b16 v[38:39], v13 offset:33792
    v_mfma_f32_16x16x32_bf16 v[164:167], v[52:55], v[24:27], v[164:167]
    ds_read_b64_tr_b16 v[40:41], v14 offset:32768
    v_mfma_f32_16x16x32_bf16 v[168:171], v[56:59], v[24:27], v[168:171]
    ds_read_b64_tr_b16 v[42:43], v14 offset:33792
    v_mfma_f32_16x16x32_bf16 v[172:175], v[60:63], v[24:27], v[172:175]
    ds_read_b128 v[24:27], v9 offset:32768
    v_mfma_f32_16x16x32_bf16 v[176:179], v[48:51], v[28:31], v[176:179]
    ds_read_b64_tr_b16 v[44:45], v15 offset:32768
    v_mfma_f32_16x16x32_bf16 v[180:183], v[52:55], v[28:31], v[180:183]
    ds_read_b64_tr_b16 v[46:47], v15 offset:33792
    v_mfma_f32_16x16x32_bf16 v[184:187], v[56:59], v[28:31], v[184:187]
    v_mfma_f32_16x16x32_bf16 v[188:191], v[60:63], v[28:31], v[188:191]
    ds_read_b128 v[28:31], v9 offset:34816
    s_waitcnt lgkmcnt(9)
    v_mfma_f32_16x16x32_bf16 v[128:131], v[32:35], v[16:19], v[128:131]
    ds_read_b64_tr_b16 v[48:49], v12 offset:40960
    s_waitcnt lgkmcnt(7)
    v_mfma_f32_16x16x32_bf16 v[132:135], v[36:39], v[16:19], v[132:135]
    ds_read_b64_tr_b16 v[50:51], v12 offset:41984
    s_waitcnt lgkmcnt(6)
    v_mfma_f32_16x16x32_bf16 v[136:139], v[40:43], v[16:19], v[136:139]
    ds_read_b64_tr_b16 v[52:53], v13 offset:40960
    s_waitcnt lgkmcnt(4)
    v_mfma_f32_16x16x32_bf16 v[140:143], v[44:47], v[16:19], v[140:143]
    ds_read_b128 v[16:19], v10 offset:32768
    v_mfma_f32_16x16x32_bf16 v[144:147], v[32:35], v[20:23], v[144:147]
    ds_read_b64_tr_b16 v[54:55], v13 offset:41984
    v_mfma_f32_16x16x32_bf16 v[148:151], v[36:39], v[20:23], v[148:151]
    ds_read_b64_tr_b16 v[56:57], v14 offset:40960
    v_mfma_f32_16x16x32_bf16 v[152:155], v[40:43], v[20:23], v[152:155]
    ds_read_b64_tr_b16 v[58:59], v14 offset:41984
    v_mfma_f32_16x16x32_bf16 v[156:159], v[44:47], v[20:23], v[156:159]
    ds_read_b128 v[20:23], v10 offset:34816
    v_mfma_f32_16x16x32_bf16 v[160:163], v[32:35], v[24:27], v[160:163]
    ds_read_b64_tr_b16 v[60:61], v15 offset:40960
    v_mfma_f32_16x16x32_bf16 v[164:167], v[36:39], v[24:27], v[164:167]
    ds_read_b64_tr_b16 v[62:63], v15 offset:41984
    v_mfma_f32_16x16x32_bf16 v[168:171], v[40:43], v[24:27], v[168:171]
    v_add_u32 v8, 0x10000, v8
    v_add_u32 v9, 0x10000, v9
    v_mfma_f32_16x16x32_bf16 v[172:175], v[44:47], v[24:27], v[172:175]
    ds_read_b128 v[24:27], v11 offset:32768
    s_waitcnt lgkmcnt(11)
    v_mfma_f32_16x16x32_bf16 v[176:179], v[32:35], v[28:31], v[176:179]
    v_add_u32 v12, 0x10000, v12
    v_mfma_f32_16x16x32_bf16 v[180:183], v[36:39], v[28:31], v[180:183]
    v_add_u32 v13, 0x10000, v13
    v_mfma_f32_16x16x32_bf16 v[184:187], v[40:43], v[28:31], v[184:187]
    v_add_u32 v14, 0x10000, v14
    v_add_u32 v15, 0x10000, v15
    v_mfma_f32_16x16x32_bf16 v[188:191], v[44:47], v[28:31], v[188:191]
    ds_read_b128 v[28:31], v11 offset:34816
    s_waitcnt lgkmcnt(8)
    v_mfma_f32_16x16x32_bf16 v[128:131], v[48:51], v[16:19], v[128:131]
    v_add_u32 v10, 0x10000, v10
    s_waitcnt lgkmcnt(7)
    v_mfma_f32_16x16x32_bf16 v[132:135], v[52:55], v[16:19], v[132:135]
    v_add_u32 v11, 0x10000, v11
    s_waitcnt lgkmcnt(5)
    v_mfma_f32_16x16x32_bf16 v[136:139], v[56:59], v[16:19], v[136:139]
    s_waitcnt lgkmcnt(2)
    v_mfma_f32_16x16x32_bf16 v[140:143], v[60:63], v[16:19], v[140:143]
    s_waitcnt lgkmcnt(0)
    s_barrier
    ds_read_b128 v[16:19], v8 offset:0
    v_mfma_f32_16x16x32_bf16 v[144:147], v[48:51], v[20:23], v[144:147]
    ds_read_b64_tr_b16 v[32:33], v12 offset:0
    v_mfma_f32_16x16x32_bf16 v[148:151], v[52:55], v[20:23], v[148:151]
    ds_read_b64_tr_b16 v[34:35], v12 offset:1024
    v_mfma_f32_16x16x32_bf16 v[152:155], v[56:59], v[20:23], v[152:155]
    ds_read_b64_tr_b16 v[36:37], v13 offset:0
    v_mfma_f32_16x16x32_bf16 v[156:159], v[60:63], v[20:23], v[156:159]
    ds_read_b128 v[20:23], v8 offset:2048
    v_mfma_f32_16x16x32_bf16 v[160:163], v[48:51], v[24:27], v[160:163]
    ds_read_b64_tr_b16 v[38:39], v13 offset:1024
    v_mfma_f32_16x16x32_bf16 v[164:167], v[52:55], v[24:27], v[164:167]
    ds_read_b64_tr_b16 v[40:41], v14 offset:0
    v_mfma_f32_16x16x32_bf16 v[168:171], v[56:59], v[24:27], v[168:171]
    ds_read_b64_tr_b16 v[42:43], v14 offset:1024
    v_mfma_f32_16x16x32_bf16 v[172:175], v[60:63], v[24:27], v[172:175]
    ds_read_b128 v[24:27], v9 offset:0
    v_mfma_f32_16x16x32_bf16 v[176:179], v[48:51], v[28:31], v[176:179]
    ds_read_b64_tr_b16 v[44:45], v15 offset:0
    v_mfma_f32_16x16x32_bf16 v[180:183], v[52:55], v[28:31], v[180:183]
    ds_read_b64_tr_b16 v[46:47], v15 offset:1024
    v_mfma_f32_16x16x32_bf16 v[184:187], v[56:59], v[28:31], v[184:187]
    v_mfma_f32_16x16x32_bf16 v[188:191], v[60:63], v[28:31], v[188:191]
    ds_read_b128 v[28:31], v9 offset:2048
    s_waitcnt lgkmcnt(9)
    v_mfma_f32_16x16x32_bf16 v[128:131], v[32:35], v[16:19], v[128:131]
    ds_read_b64_tr_b16 v[48:49], v12 offset:8192
    s_waitcnt lgkmcnt(7)
    v_mfma_f32_16x16x32_bf16 v[132:135], v[36:39], v[16:19], v[132:135]
    ds_read_b64_tr_b16 v[50:51], v12 offset:9216
    s_waitcnt lgkmcnt(6)
    v_mfma_f32_16x16x32_bf16 v[136:139], v[40:43], v[16:19], v[136:139]
    ds_read_b64_tr_b16 v[52:53], v13 offset:8192
    s_waitcnt lgkmcnt(4)
    v_mfma_f32_16x16x32_bf16 v[140:143], v[44:47], v[16:19], v[140:143]
    ds_read_b128 v[16:19], v10 offset:0
    v_mfma_f32_16x16x32_bf16 v[144:147], v[32:35], v[20:23], v[144:147]
    ds_read_b64_tr_b16 v[54:55], v13 offset:9216
    v_mfma_f32_16x16x32_bf16 v[148:151], v[36:39], v[20:23], v[148:151]
    ds_read_b64_tr_b16 v[56:57], v14 offset:8192
    v_mfma_f32_16x16x32_bf16 v[152:155], v[40:43], v[20:23], v[152:155]
    ds_read_b64_tr_b16 v[58:59], v14 offset:9216
    v_mfma_f32_16x16x32_bf16 v[156:159], v[44:47], v[20:23], v[156:159]
    ds_read_b128 v[20:23], v10 offset:2048
    v_mfma_f32_16x16x32_bf16 v[160:163], v[32:35], v[24:27], v[160:163]
    ds_read_b64_tr_b16 v[60:61], v15 offset:8192
    v_mfma_f32_16x16x32_bf16 v[164:167], v[36:39], v[24:27], v[164:167]
    ds_read_b64_tr_b16 v[62:63], v15 offset:9216
    v_mfma_f32_16x16x32_bf16 v[168:171], v[40:43], v[24:27], v[168:171]
    v_mfma_f32_16x16x32_bf16 v[172:175], v[44:47], v[24:27], v[172:175]
    ds_read_b128 v[24:27], v11 offset:0
    s_waitcnt lgkmcnt(11)
    v_mfma_f32_16x16x32_bf16 v[176:179], v[32:35], v[28:31], v[176:179]
    v_mfma_f32_16x16x32_bf16 v[180:183], v[36:39], v[28:31], v[180:183]
    v_mfma_f32_16x16x32_bf16 v[184:187], v[40:43], v[28:31], v[184:187]
    v_mfma_f32_16x16x32_bf16 v[188:191], v[44:47], v[28:31], v[188:191]
    ds_read_b128 v[28:31], v11 offset:2048
    s_waitcnt lgkmcnt(8)
    v_mfma_f32_16x16x32_bf16 v[128:131], v[48:51], v[16:19], v[128:131]
    s_waitcnt lgkmcnt(7)
    v_mfma_f32_16x16x32_bf16 v[132:135], v[52:55], v[16:19], v[132:135]
    s_waitcnt lgkmcnt(5)
    v_mfma_f32_16x16x32_bf16 v[136:139], v[56:59], v[16:19], v[136:139]
    s_waitcnt lgkmcnt(2)
    v_mfma_f32_16x16x32_bf16 v[140:143], v[60:63], v[16:19], v[140:143]
    s_waitcnt lgkmcnt(0)
    s_barrier
    ds_read_b128 v[16:19], v8 offset:32768
    v_mfma_f32_16x16x32_bf16 v[144:147], v[48:51], v[20:23], v[144:147]
    ds_read_b64_tr_b16 v[32:33], v12 offset:32768
    v_mfma_f32_16x16x32_bf16 v[148:151], v[52:55], v[20:23], v[148:151]
    ds_read_b64_tr_b16 v[34:35], v12 offset:33792
    v_mfma_f32_16x16x32_bf16 v[152:155], v[56:59], v[20:23], v[152:155]
    ds_read_b64_tr_b16 v[36:37], v13 offset:32768
    v_mfma_f32_16x16x32_bf16 v[156:159], v[60:63], v[20:23], v[156:159]
    ds_read_b128 v[20:23], v8 offset:34816
    v_mfma_f32_16x16x32_bf16 v[160:163], v[48:51], v[24:27], v[160:163]
    ds_read_b64_tr_b16 v[38:39], v13 offset:33792
    v_mfma_f32_16x16x32_bf16 v[164:167], v[52:55], v[24:27], v[164:167]
    ds_read_b64_tr_b16 v[40:41], v14 offset:32768
    v_mfma_f32_16x16x32_bf16 v[168:171], v[56:59], v[24:27], v[168:171]
    ds_read_b64_tr_b16 v[42:43], v14 offset:33792
    v_mfma_f32_16x16x32_bf16 v[172:175], v[60:63], v[24:27], v[172:175]
    ds_read_b128 v[24:27], v9 offset:32768
    v_mfma_f32_16x16x32_bf16 v[176:179], v[48:51], v[28:31], v[176:179]
    ds_read_b64_tr_b16 v[44:45], v15 offset:32768
    v_mfma_f32_16x16x32_bf16 v[180:183], v[52:55], v[28:31], v[180:183]
    ds_read_b64_tr_b16 v[46:47], v15 offset:33792
    v_mfma_f32_16x16x32_bf16 v[184:187], v[56:59], v[28:31], v[184:187]
    v_mfma_f32_16x16x32_bf16 v[188:191], v[60:63], v[28:31], v[188:191]
    ds_read_b128 v[28:31], v9 offset:34816
    s_waitcnt lgkmcnt(9)
    v_mfma_f32_16x16x32_bf16 v[128:131], v[32:35], v[16:19], v[128:131]
    ds_read_b64_tr_b16 v[48:49], v12 offset:40960
    s_waitcnt lgkmcnt(7)
    v_mfma_f32_16x16x32_bf16 v[132:135], v[36:39], v[16:19], v[132:135]
    ds_read_b64_tr_b16 v[50:51], v12 offset:41984
    s_waitcnt lgkmcnt(6)
    v_mfma_f32_16x16x32_bf16 v[136:139], v[40:43], v[16:19], v[136:139]
    ds_read_b64_tr_b16 v[52:53], v13 offset:40960
    s_waitcnt lgkmcnt(4)
    v_mfma_f32_16x16x32_bf16 v[140:143], v[44:47], v[16:19], v[140:143]
    ds_read_b128 v[16:19], v10 offset:32768
    v_mfma_f32_16x16x32_bf16 v[144:147], v[32:35], v[20:23], v[144:147]
    ds_read_b64_tr_b16 v[54:55], v13 offset:41984
    v_mfma_f32_16x16x32_bf16 v[148:151], v[36:39], v[20:23], v[148:151]
    ds_read_b64_tr_b16 v[56:57], v14 offset:40960
    v_mfma_f32_16x16x32_bf16 v[152:155], v[40:43], v[20:23], v[152:155]
    ds_read_b64_tr_b16 v[58:59], v14 offset:41984
    v_mfma_f32_16x16x32_bf16 v[156:159], v[44:47], v[20:23], v[156:159]
    ds_read_b128 v[20:23], v10 offset:34816
    v_mfma_f32_16x16x32_bf16 v[160:163], v[32:35], v[24:27], v[160:163]
    ds_read_b64_tr_b16 v[60:61], v15 offset:40960
    v_mfma_f32_16x16x32_bf16 v[164:167], v[36:39], v[24:27], v[164:167]
    ds_read_b64_tr_b16 v[62:63], v15 offset:41984
    v_mfma_f32_16x16x32_bf16 v[168:171], v[40:43], v[24:27], v[168:171]
    v_add_u32 v8, 0xffff0000, v8
    v_add_u32 v9, 0xffff0000, v9
    v_mfma_f32_16x16x32_bf16 v[172:175], v[44:47], v[24:27], v[172:175]
    ds_read_b128 v[24:27], v11 offset:32768
    s_waitcnt lgkmcnt(11)
    v_mfma_f32_16x16x32_bf16 v[176:179], v[32:35], v[28:31], v[176:179]
    v_add_u32 v12, 0xffff0000, v12
    v_mfma_f32_16x16x32_bf16 v[180:183], v[36:39], v[28:31], v[180:183]
    v_add_u32 v13, 0xffff0000, v13
    v_mfma_f32_16x16x32_bf16 v[184:187], v[40:43], v[28:31], v[184:187]
    v_add_u32 v14, 0xffff0000, v14
    v_add_u32 v15, 0xffff0000, v15
    v_mfma_f32_16x16x32_bf16 v[188:191], v[44:47], v[28:31], v[188:191]
    ds_read_b128 v[28:31], v11 offset:34816
    s_waitcnt lgkmcnt(8)
    v_mfma_f32_16x16x32_bf16 v[128:131], v[48:51], v[16:19], v[128:131]
    v_add_u32 v10, 0xffff0000, v10
    s_waitcnt lgkmcnt(7)
    v_mfma_f32_16x16x32_bf16 v[132:135], v[52:55], v[16:19], v[132:135]
    v_add_u32 v11, 0xffff0000, v11
    s_waitcnt lgkmcnt(5)
    v_mfma_f32_16x16x32_bf16 v[136:139], v[56:59], v[16:19], v[136:139]
    s_waitcnt lgkmcnt(2)
    v_mfma_f32_16x16x32_bf16 v[140:143], v[60:63], v[16:19], v[140:143]
    s_waitcnt lgkmcnt(0)
    s_barrier
    ds_read_b128 v[16:19], v8 offset:0
    v_mfma_f32_16x16x32_bf16 v[144:147], v[48:51], v[20:23], v[144:147]
    ds_read_b64_tr_b16 v[32:33], v12 offset:0
    v_mfma_f32_16x16x32_bf16 v[148:151], v[52:55], v[20:23], v[148:151]
    ds_read_b64_tr_b16 v[34:35], v12 offset:1024
    v_mfma_f32_16x16x32_bf16 v[152:155], v[56:59], v[20:23], v[152:155]
    ds_read_b64_tr_b16 v[36:37], v13 offset:0
    v_mfma_f32_16x16x32_bf16 v[156:159], v[60:63], v[20:23], v[156:159]
    ds_read_b128 v[20:23], v8 offset:2048
    v_mfma_f32_16x16x32_bf16 v[160:163], v[48:51], v[24:27], v[160:163]
    ds_read_b64_tr_b16 v[38:39], v13 offset:1024
    v_mfma_f32_16x16x32_bf16 v[164:167], v[52:55], v[24:27], v[164:167]
    ds_read_b64_tr_b16 v[40:41], v14 offset:0
    v_mfma_f32_16x16x32_bf16 v[168:171], v[56:59], v[24:27], v[168:171]
    ds_read_b64_tr_b16 v[42:43], v14 offset:1024
    v_mfma_f32_16x16x32_bf16 v[172:175], v[60:63], v[24:27], v[172:175]
    ds_read_b128 v[24:27], v9 offset:0
    v_mfma_f32_16x16x32_bf16 v[176:179], v[48:51], v[28:31], v[176:179]
    ds_read_b64_tr_b16 v[44:45], v15 offset:0
    v_mfma_f32_16x16x32_bf16 v[180:183], v[52:55], v[28:31], v[180:183]
    ds_read_b64_tr_b16 v[46:47], v15 offset:1024
    v_mfma_f32_16x16x32_bf16 v[184:187], v[56:59], v[28:31], v[184:187]
    v_mfma_f32_16x16x32_bf16 v[188:191], v[60:63], v[28:31], v[188:191]
    ds_read_b128 v[28:31], v9 offset:2048
    s_waitcnt lgkmcnt(9)
    v_mfma_f32_16x16x32_bf16 v[128:131], v[32:35], v[16:19], v[128:131]
    ds_read_b64_tr_b16 v[48:49], v12 offset:8192
    s_waitcnt lgkmcnt(7)
    v_mfma_f32_16x16x32_bf16 v[132:135], v[36:39], v[16:19], v[132:135]
    ds_read_b64_tr_b16 v[50:51], v12 offset:9216
    s_waitcnt lgkmcnt(6)
    v_mfma_f32_16x16x32_bf16 v[136:139], v[40:43], v[16:19], v[136:139]
    ds_read_b64_tr_b16 v[52:53], v13 offset:8192
    s_waitcnt lgkmcnt(4)
    v_mfma_f32_16x16x32_bf16 v[140:143], v[44:47], v[16:19], v[140:143]
    ds_read_b128 v[16:19], v10 offset:0
    v_mfma_f32_16x16x32_bf16 v[144:147], v[32:35], v[20:23], v[144:147]
    ds_read_b64_tr_b16 v[54:55], v13 offset:9216
    v_mfma_f32_16x16x32_bf16 v[148:151], v[36:39], v[20:23], v[148:151]
    ds_read_b64_tr_b16 v[56:57], v14 offset:8192
    v_mfma_f32_16x16x32_bf16 v[152:155], v[40:43], v[20:23], v[152:155]
    ds_read_b64_tr_b16 v[58:59], v14 offset:9216
    v_mfma_f32_16x16x32_bf16 v[156:159], v[44:47], v[20:23], v[156:159]
    ds_read_b128 v[20:23], v10 offset:2048
    v_mfma_f32_16x16x32_bf16 v[160:163], v[32:35], v[24:27], v[160:163]
    ds_read_b64_tr_b16 v[60:61], v15 offset:8192
    v_mfma_f32_16x16x32_bf16 v[164:167], v[36:39], v[24:27], v[164:167]
    ds_read_b64_tr_b16 v[62:63], v15 offset:9216
    v_mfma_f32_16x16x32_bf16 v[168:171], v[40:43], v[24:27], v[168:171]
    v_mfma_f32_16x16x32_bf16 v[172:175], v[44:47], v[24:27], v[172:175]
    ds_read_b128 v[24:27], v11 offset:0
    s_waitcnt lgkmcnt(11)
    v_mfma_f32_16x16x32_bf16 v[176:179], v[32:35], v[28:31], v[176:179]
    v_mfma_f32_16x16x32_bf16 v[180:183], v[36:39], v[28:31], v[180:183]
    v_mfma_f32_16x16x32_bf16 v[184:187], v[40:43], v[28:31], v[184:187]
    v_mfma_f32_16x16x32_bf16 v[188:191], v[44:47], v[28:31], v[188:191]
    ds_read_b128 v[28:31], v11 offset:2048
    s_waitcnt lgkmcnt(8)
    v_mfma_f32_16x16x32_bf16 v[128:131], v[48:51], v[16:19], v[128:131]
    s_waitcnt lgkmcnt(7)
    v_mfma_f32_16x16x32_bf16 v[132:135], v[52:55], v[16:19], v[132:135]
    s_waitcnt lgkmcnt(5)
    v_mfma_f32_16x16x32_bf16 v[136:139], v[56:59], v[16:19], v[136:139]
    s_waitcnt lgkmcnt(2)
    v_mfma_f32_16x16x32_bf16 v[140:143], v[60:63], v[16:19], v[140:143]
    s_waitcnt lgkmcnt(0)
    s_barrier
    ds_read_b128 v[16:19], v8 offset:32768
    v_mfma_f32_16x16x32_bf16 v[144:147], v[48:51], v[20:23], v[144:147]
    ds_read_b64_tr_b16 v[32:33], v12 offset:32768
    v_mfma_f32_16x16x32_bf16 v[148:151], v[52:55], v[20:23], v[148:151]
    ds_read_b64_tr_b16 v[34:35], v12 offset:33792
    v_mfma_f32_16x16x32_bf16 v[152:155], v[56:59], v[20:23], v[152:155]
    ds_read_b64_tr_b16 v[36:37], v13 offset:32768
    v_mfma_f32_16x16x32_bf16 v[156:159], v[60:63], v[20:23], v[156:159]
    ds_read_b128 v[20:23], v8 offset:34816
    v_mfma_f32_16x16x32_bf16 v[160:163], v[48:51], v[24:27], v[160:163]
    ds_read_b64_tr_b16 v[38:39], v13 offset:33792
    v_mfma_f32_16x16x32_bf16 v[164:167], v[52:55], v[24:27], v[164:167]
    ds_read_b64_tr_b16 v[40:41], v14 offset:32768
    v_mfma_f32_16x16x32_bf16 v[168:171], v[56:59], v[24:27], v[168:171]
    ds_read_b64_tr_b16 v[42:43], v14 offset:33792
    v_mfma_f32_16x16x32_bf16 v[172:175], v[60:63], v[24:27], v[172:175]
    ds_read_b128 v[24:27], v9 offset:32768
    v_mfma_f32_16x16x32_bf16 v[176:179], v[48:51], v[28:31], v[176:179]
    ds_read_b64_tr_b16 v[44:45], v15 offset:32768
    v_mfma_f32_16x16x32_bf16 v[180:183], v[52:55], v[28:31], v[180:183]
    ds_read_b64_tr_b16 v[46:47], v15 offset:33792
    v_mfma_f32_16x16x32_bf16 v[184:187], v[56:59], v[28:31], v[184:187]
    v_mfma_f32_16x16x32_bf16 v[188:191], v[60:63], v[28:31], v[188:191]
    ds_read_b128 v[28:31], v9 offset:34816
    s_waitcnt lgkmcnt(9)
    v_mfma_f32_16x16x32_bf16 v[128:131], v[32:35], v[16:19], v[128:131]
    ds_read_b64_tr_b16 v[48:49], v12 offset:40960
    s_waitcnt lgkmcnt(7)
    v_mfma_f32_16x16x32_bf16 v[132:135], v[36:39], v[16:19], v[132:135]
    ds_read_b64_tr_b16 v[50:51], v12 offset:41984
    s_waitcnt lgkmcnt(6)
    v_mfma_f32_16x16x32_bf16 v[136:139], v[40:43], v[16:19], v[136:139]
    ds_read_b64_tr_b16 v[52:53], v13 offset:40960
    s_waitcnt lgkmcnt(4)
    v_mfma_f32_16x16x32_bf16 v[140:143], v[44:47], v[16:19], v[140:143]
    ds_read_b128 v[16:19], v10 offset:32768
    v_mfma_f32_16x16x32_bf16 v[144:147], v[32:35], v[20:23], v[144:147]
    ds_read_b64_tr_b16 v[54:55], v13 offset:41984
    v_mfma_f32_16x16x32_bf16 v[148:151], v[36:39], v[20:23], v[148:151]
    ds_read_b64_tr_b16 v[56:57], v14 offset:40960
    v_mfma_f32_16x16x32_bf16 v[152:155], v[40:43], v[20:23], v[152:155]
    ds_read_b64_tr_b16 v[58:59], v14 offset:41984
    v_mfma_f32_16x16x32_bf16 v[156:159], v[44:47], v[20:23], v[156:159]
    ds_read_b128 v[20:23], v10 offset:34816
    v_mfma_f32_16x16x32_bf16 v[160:163], v[32:35], v[24:27], v[160:163]
    ds_read_b64_tr_b16 v[60:61], v15 offset:40960
    v_mfma_f32_16x16x32_bf16 v[164:167], v[36:39], v[24:27], v[164:167]
    ds_read_b64_tr_b16 v[62:63], v15 offset:41984
    v_mfma_f32_16x16x32_bf16 v[168:171], v[40:43], v[24:27], v[168:171]
    v_add_u32 v8, 0x10000, v8
    v_add_u32 v9, 0x10000, v9
    v_mfma_f32_16x16x32_bf16 v[172:175], v[44:47], v[24:27], v[172:175]
    ds_read_b128 v[24:27], v11 offset:32768
    s_waitcnt lgkmcnt(11)
    v_mfma_f32_16x16x32_bf16 v[176:179], v[32:35], v[28:31], v[176:179]
    v_add_u32 v12, 0x10000, v12
    v_mfma_f32_16x16x32_bf16 v[180:183], v[36:39], v[28:31], v[180:183]
    v_add_u32 v13, 0x10000, v13
    v_mfma_f32_16x16x32_bf16 v[184:187], v[40:43], v[28:31], v[184:187]
    v_add_u32 v14, 0x10000, v14
    v_add_u32 v15, 0x10000, v15
    v_mfma_f32_16x16x32_bf16 v[188:191], v[44:47], v[28:31], v[188:191]
    ds_read_b128 v[28:31], v11 offset:34816
    s_waitcnt lgkmcnt(8)
    v_mfma_f32_16x16x32_bf16 v[128:131], v[48:51], v[16:19], v[128:131]
    v_add_u32 v10, 0x10000, v10
    s_waitcnt lgkmcnt(7)
    v_mfma_f32_16x16x32_bf16 v[132:135], v[52:55], v[16:19], v[132:135]
    v_add_u32 v11, 0x10000, v11
    s_waitcnt lgkmcnt(5)
    v_mfma_f32_16x16x32_bf16 v[136:139], v[56:59], v[16:19], v[136:139]
    s_waitcnt lgkmcnt(2)
    v_mfma_f32_16x16x32_bf16 v[140:143], v[60:63], v[16:19], v[140:143]
    s_waitcnt lgkmcnt(0)
    s_barrier
    ds_read_b128 v[16:19], v8 offset:0
    v_mfma_f32_16x16x32_bf16 v[144:147], v[48:51], v[20:23], v[144:147]
    ds_read_b64_tr_b16 v[32:33], v12 offset:0
    v_mfma_f32_16x16x32_bf16 v[148:151], v[52:55], v[20:23], v[148:151]
    ds_read_b64_tr_b16 v[34:35], v12 offset:1024
    v_mfma_f32_16x16x32_bf16 v[152:155], v[56:59], v[20:23], v[152:155]
    ds_read_b64_tr_b16 v[36:37], v13 offset:0
    v_mfma_f32_16x16x32_bf16 v[156:159], v[60:63], v[20:23], v[156:159]
    ds_read_b128 v[20:23], v8 offset:2048
    v_mfma_f32_16x16x32_bf16 v[160:163], v[48:51], v[24:27], v[160:163]
    ds_read_b64_tr_b16 v[38:39], v13 offset:1024
    v_mfma_f32_16x16x32_bf16 v[164:167], v[52:55], v[24:27], v[164:167]
    ds_read_b64_tr_b16 v[40:41], v14 offset:0
    v_mfma_f32_16x16x32_bf16 v[168:171], v[56:59], v[24:27], v[168:171]
    ds_read_b64_tr_b16 v[42:43], v14 offset:1024
    v_mfma_f32_16x16x32_bf16 v[172:175], v[60:63], v[24:27], v[172:175]
    ds_read_b128 v[24:27], v9 offset:0
    v_mfma_f32_16x16x32_bf16 v[176:179], v[48:51], v[28:31], v[176:179]
    ds_read_b64_tr_b16 v[44:45], v15 offset:0
    v_mfma_f32_16x16x32_bf16 v[180:183], v[52:55], v[28:31], v[180:183]
    ds_read_b64_tr_b16 v[46:47], v15 offset:1024
    v_mfma_f32_16x16x32_bf16 v[184:187], v[56:59], v[28:31], v[184:187]
    v_mfma_f32_16x16x32_bf16 v[188:191], v[60:63], v[28:31], v[188:191]
    ds_read_b128 v[28:31], v9 offset:2048
    s_waitcnt lgkmcnt(9)
    v_mfma_f32_16x16x32_bf16 v[128:131], v[32:35], v[16:19], v[128:131]
    ds_read_b64_tr_b16 v[48:49], v12 offset:8192
    s_waitcnt lgkmcnt(7)
    v_mfma_f32_16x16x32_bf16 v[132:135], v[36:39], v[16:19], v[132:135]
    ds_read_b64_tr_b16 v[50:51], v12 offset:9216
    s_waitcnt lgkmcnt(6)
    v_mfma_f32_16x16x32_bf16 v[136:139], v[40:43], v[16:19], v[136:139]
    ds_read_b64_tr_b16 v[52:53], v13 offset:8192
    s_waitcnt lgkmcnt(4)
    v_mfma_f32_16x16x32_bf16 v[140:143], v[44:47], v[16:19], v[140:143]
    ds_read_b128 v[16:19], v10 offset:0
    v_mfma_f32_16x16x32_bf16 v[144:147], v[32:35], v[20:23], v[144:147]
    ds_read_b64_tr_b16 v[54:55], v13 offset:9216
    v_mfma_f32_16x16x32_bf16 v[148:151], v[36:39], v[20:23], v[148:151]
    ds_read_b64_tr_b16 v[56:57], v14 offset:8192
    v_mfma_f32_16x16x32_bf16 v[152:155], v[40:43], v[20:23], v[152:155]
    ds_read_b64_tr_b16 v[58:59], v14 offset:9216
    v_mfma_f32_16x16x32_bf16 v[156:159], v[44:47], v[20:23], v[156:159]
    ds_read_b128 v[20:23], v10 offset:2048
    v_mfma_f32_16x16x32_bf16 v[160:163], v[32:35], v[24:27], v[160:163]
    ds_read_b64_tr_b16 v[60:61], v15 offset:8192
    v_mfma_f32_16x16x32_bf16 v[164:167], v[36:39], v[24:27], v[164:167]
    ds_read_b64_tr_b16 v[62:63], v15 offset:9216
    v_mfma_f32_16x16x32_bf16 v[168:171], v[40:43], v[24:27], v[168:171]
    v_mfma_f32_16x16x32_bf16 v[172:175], v[44:47], v[24:27], v[172:175]
    ds_read_b128 v[24:27], v11 offset:0
    s_waitcnt lgkmcnt(11)
    v_mfma_f32_16x16x32_bf16 v[176:179], v[32:35], v[28:31], v[176:179]
    v_mfma_f32_16x16x32_bf16 v[180:183], v[36:39], v[28:31], v[180:183]
    v_mfma_f32_16x16x32_bf16 v[184:187], v[40:43], v[28:31], v[184:187]
    v_mfma_f32_16x16x32_bf16 v[188:191], v[44:47], v[28:31], v[188:191]
    ds_read_b128 v[28:31], v11 offset:2048
    s_waitcnt lgkmcnt(8)
    v_mfma_f32_16x16x32_bf16 v[128:131], v[48:51], v[16:19], v[128:131]
    s_waitcnt lgkmcnt(7)
    v_mfma_f32_16x16x32_bf16 v[132:135], v[52:55], v[16:19], v[132:135]
    s_waitcnt lgkmcnt(5)
    v_mfma_f32_16x16x32_bf16 v[136:139], v[56:59], v[16:19], v[136:139]
    s_waitcnt lgkmcnt(2)
    v_mfma_f32_16x16x32_bf16 v[140:143], v[60:63], v[16:19], v[140:143]
    s_waitcnt lgkmcnt(0)
    s_barrier
    ds_read_b128 v[16:19], v8 offset:32768
    v_mfma_f32_16x16x32_bf16 v[144:147], v[48:51], v[20:23], v[144:147]
    ds_read_b64_tr_b16 v[32:33], v12 offset:32768
    v_mfma_f32_16x16x32_bf16 v[148:151], v[52:55], v[20:23], v[148:151]
    ds_read_b64_tr_b16 v[34:35], v12 offset:33792
    v_mfma_f32_16x16x32_bf16 v[152:155], v[56:59], v[20:23], v[152:155]
    ds_read_b64_tr_b16 v[36:37], v13 offset:32768
    v_mfma_f32_16x16x32_bf16 v[156:159], v[60:63], v[20:23], v[156:159]
    ds_read_b128 v[20:23], v8 offset:34816
    v_mfma_f32_16x16x32_bf16 v[160:163], v[48:51], v[24:27], v[160:163]
    ds_read_b64_tr_b16 v[38:39], v13 offset:33792
    v_mfma_f32_16x16x32_bf16 v[164:167], v[52:55], v[24:27], v[164:167]
    ds_read_b64_tr_b16 v[40:41], v14 offset:32768
    v_mfma_f32_16x16x32_bf16 v[168:171], v[56:59], v[24:27], v[168:171]
    ds_read_b64_tr_b16 v[42:43], v14 offset:33792
    v_mfma_f32_16x16x32_bf16 v[172:175], v[60:63], v[24:27], v[172:175]
    ds_read_b128 v[24:27], v9 offset:32768
    v_mfma_f32_16x16x32_bf16 v[176:179], v[48:51], v[28:31], v[176:179]
    ds_read_b64_tr_b16 v[44:45], v15 offset:32768
    v_mfma_f32_16x16x32_bf16 v[180:183], v[52:55], v[28:31], v[180:183]
    ds_read_b64_tr_b16 v[46:47], v15 offset:33792
    v_mfma_f32_16x16x32_bf16 v[184:187], v[56:59], v[28:31], v[184:187]
    v_mfma_f32_16x16x32_bf16 v[188:191], v[60:63], v[28:31], v[188:191]
    ds_read_b128 v[28:31], v9 offset:34816
    s_waitcnt lgkmcnt(9)
    v_mfma_f32_16x16x32_bf16 v[128:131], v[32:35], v[16:19], v[128:131]
    ds_read_b64_tr_b16 v[48:49], v12 offset:40960
    s_waitcnt lgkmcnt(7)
    v_mfma_f32_16x16x32_bf16 v[132:135], v[36:39], v[16:19], v[132:135]
    ds_read_b64_tr_b16 v[50:51], v12 offset:41984
    s_waitcnt lgkmcnt(6)
    v_mfma_f32_16x16x32_bf16 v[136:139], v[40:43], v[16:19], v[136:139]
    ds_read_b64_tr_b16 v[52:53], v13 offset:40960
    s_waitcnt lgkmcnt(4)
    v_mfma_f32_16x16x32_bf16 v[140:143], v[44:47], v[16:19], v[140:143]
    ds_read_b128 v[16:19], v10 offset:32768
    v_mfma_f32_16x16x32_bf16 v[144:147], v[32:35], v[20:23], v[144:147]
    ds_read_b64_tr_b16 v[54:55], v13 offset:41984
    v_mfma_f32_16x16x32_bf16 v[148:151], v[36:39], v[20:23], v[148:151]
    ds_read_b64_tr_b16 v[56:57], v14 offset:40960
    v_mfma_f32_16x16x32_bf16 v[152:155], v[40:43], v[20:23], v[152:155]
    ds_read_b64_tr_b16 v[58:59], v14 offset:41984
    v_mfma_f32_16x16x32_bf16 v[156:159], v[44:47], v[20:23], v[156:159]
    ds_read_b128 v[20:23], v10 offset:34816
    v_mfma_f32_16x16x32_bf16 v[160:163], v[32:35], v[24:27], v[160:163]
    ds_read_b64_tr_b16 v[60:61], v15 offset:40960
    v_mfma_f32_16x16x32_bf16 v[164:167], v[36:39], v[24:27], v[164:167]
    ds_read_b64_tr_b16 v[62:63], v15 offset:41984
    v_mfma_f32_16x16x32_bf16 v[168:171], v[40:43], v[24:27], v[168:171]
    v_add_u32 v8, 0xffff0000, v8
    v_add_u32 v9, 0xffff0000, v9
    v_mfma_f32_16x16x32_bf16 v[172:175], v[44:47], v[24:27], v[172:175]
    ds_read_b128 v[24:27], v11 offset:32768
    s_waitcnt lgkmcnt(11)
    v_mfma_f32_16x16x32_bf16 v[176:179], v[32:35], v[28:31], v[176:179]
    v_add_u32 v12, 0xffff0000, v12
    v_mfma_f32_16x16x32_bf16 v[180:183], v[36:39], v[28:31], v[180:183]
    v_add_u32 v13, 0xffff0000, v13
    v_mfma_f32_16x16x32_bf16 v[184:187], v[40:43], v[28:31], v[184:187]
    v_add_u32 v14, 0xffff0000, v14
    v_add_u32 v15, 0xffff0000, v15
    v_mfma_f32_16x16x32_bf16 v[188:191], v[44:47], v[28:31], v[188:191]
    ds_read_b128 v[28:31], v11 offset:34816
    s_waitcnt lgkmcnt(8)
    v_mfma_f32_16x16x32_bf16 v[128:131], v[48:51], v[16:19], v[128:131]
    v_add_u32 v10, 0xffff0000, v10
    s_waitcnt lgkmcnt(7)
    v_mfma_f32_16x16x32_bf16 v[132:135], v[52:55], v[16:19], v[132:135]
    v_add_u32 v11, 0xffff0000, v11
    s_waitcnt lgkmcnt(5)
    v_mfma_f32_16x16x32_bf16 v[136:139], v[56:59], v[16:19], v[136:139]
    s_waitcnt lgkmcnt(2)
    v_mfma_f32_16x16x32_bf16 v[140:143], v[60:63], v[16:19], v[140:143]
    s_waitcnt lgkmcnt(0)
    s_barrier
    ds_read_b128 v[16:19], v8 offset:0
    v_mfma_f32_16x16x32_bf16 v[144:147], v[48:51], v[20:23], v[144:147]
    ds_read_b64_tr_b16 v[32:33], v12 offset:0
    v_mfma_f32_16x16x32_bf16 v[148:151], v[52:55], v[20:23], v[148:151]
    ds_read_b64_tr_b16 v[34:35], v12 offset:1024
    v_mfma_f32_16x16x32_bf16 v[152:155], v[56:59], v[20:23], v[152:155]
    ds_read_b64_tr_b16 v[36:37], v13 offset:0
    v_mfma_f32_16x16x32_bf16 v[156:159], v[60:63], v[20:23], v[156:159]
    ds_read_b128 v[20:23], v8 offset:2048
    v_mfma_f32_16x16x32_bf16 v[160:163], v[48:51], v[24:27], v[160:163]
    ds_read_b64_tr_b16 v[38:39], v13 offset:1024
    v_mfma_f32_16x16x32_bf16 v[164:167], v[52:55], v[24:27], v[164:167]
    ds_read_b64_tr_b16 v[40:41], v14 offset:0
    v_mfma_f32_16x16x32_bf16 v[168:171], v[56:59], v[24:27], v[168:171]
    ds_read_b64_tr_b16 v[42:43], v14 offset:1024
    v_mfma_f32_16x16x32_bf16 v[172:175], v[60:63], v[24:27], v[172:175]
    ds_read_b128 v[24:27], v9 offset:0
    v_mfma_f32_16x16x32_bf16 v[176:179], v[48:51], v[28:31], v[176:179]
    ds_read_b64_tr_b16 v[44:45], v15 offset:0
    v_mfma_f32_16x16x32_bf16 v[180:183], v[52:55], v[28:31], v[180:183]
    ds_read_b64_tr_b16 v[46:47], v15 offset:1024
    v_mfma_f32_16x16x32_bf16 v[184:187], v[56:59], v[28:31], v[184:187]
    v_mfma_f32_16x16x32_bf16 v[188:191], v[60:63], v[28:31], v[188:191]
    ds_read_b128 v[28:31], v9 offset:2048
    s_waitcnt lgkmcnt(9)
    v_mfma_f32_16x16x32_bf16 v[128:131], v[32:35], v[16:19], v[128:131]
    ds_read_b64_tr_b16 v[48:49], v12 offset:8192
    s_waitcnt lgkmcnt(7)
    v_mfma_f32_16x16x32_bf16 v[132:135], v[36:39], v[16:19], v[132:135]
    ds_read_b64_tr_b16 v[50:51], v12 offset:9216
    s_waitcnt lgkmcnt(6)
    v_mfma_f32_16x16x32_bf16 v[136:139], v[40:43], v[16:19], v[136:139]
    ds_read_b64_tr_b16 v[52:53], v13 offset:8192
    s_waitcnt lgkmcnt(4)
    v_mfma_f32_16x16x32_bf16 v[140:143], v[44:47], v[16:19], v[140:143]
    ds_read_b128 v[16:19], v10 offset:0
    v_mfma_f32_16x16x32_bf16 v[144:147], v[32:35], v[20:23], v[144:147]
    ds_read_b64_tr_b16 v[54:55], v13 offset:9216
    v_mfma_f32_16x16x32_bf16 v[148:151], v[36:39], v[20:23], v[148:151]
    ds_read_b64_tr_b16 v[56:57], v14 offset:8192
    v_mfma_f32_16x16x32_bf16 v[152:155], v[40:43], v[20:23], v[152:155]
    ds_read_b64_tr_b16 v[58:59], v14 offset:9216
    v_mfma_f32_16x16x32_bf16 v[156:159], v[44:47], v[20:23], v[156:159]
    ds_read_b128 v[20:23], v10 offset:2048
    v_mfma_f32_16x16x32_bf16 v[160:163], v[32:35], v[24:27], v[160:163]
    ds_read_b64_tr_b16 v[60:61], v15 offset:8192
    v_mfma_f32_16x16x32_bf16 v[164:167], v[36:39], v[24:27], v[164:167]
    ds_read_b64_tr_b16 v[62:63], v15 offset:9216
    v_mfma_f32_16x16x32_bf16 v[168:171], v[40:43], v[24:27], v[168:171]
    v_mfma_f32_16x16x32_bf16 v[172:175], v[44:47], v[24:27], v[172:175]
    ds_read_b128 v[24:27], v11 offset:0
    s_waitcnt lgkmcnt(11)
    v_mfma_f32_16x16x32_bf16 v[176:179], v[32:35], v[28:31], v[176:179]
    v_mfma_f32_16x16x32_bf16 v[180:183], v[36:39], v[28:31], v[180:183]
    v_mfma_f32_16x16x32_bf16 v[184:187], v[40:43], v[28:31], v[184:187]
    v_mfma_f32_16x16x32_bf16 v[188:191], v[44:47], v[28:31], v[188:191]
    ds_read_b128 v[28:31], v11 offset:2048
    s_waitcnt lgkmcnt(8)
    v_mfma_f32_16x16x32_bf16 v[128:131], v[48:51], v[16:19], v[128:131]
    s_waitcnt lgkmcnt(7)
    v_mfma_f32_16x16x32_bf16 v[132:135], v[52:55], v[16:19], v[132:135]
    s_waitcnt lgkmcnt(5)
    v_mfma_f32_16x16x32_bf16 v[136:139], v[56:59], v[16:19], v[136:139]
    s_waitcnt lgkmcnt(2)
    v_mfma_f32_16x16x32_bf16 v[140:143], v[60:63], v[16:19], v[140:143]
    s_waitcnt lgkmcnt(0)
    s_barrier
    ds_read_b128 v[16:19], v8 offset:32768
    v_mfma_f32_16x16x32_bf16 v[144:147], v[48:51], v[20:23], v[144:147]
    ds_read_b64_tr_b16 v[32:33], v12 offset:32768
    v_mfma_f32_16x16x32_bf16 v[148:151], v[52:55], v[20:23], v[148:151]
    ds_read_b64_tr_b16 v[34:35], v12 offset:33792
    v_mfma_f32_16x16x32_bf16 v[152:155], v[56:59], v[20:23], v[152:155]
    ds_read_b64_tr_b16 v[36:37], v13 offset:32768
    v_mfma_f32_16x16x32_bf16 v[156:159], v[60:63], v[20:23], v[156:159]
    ds_read_b128 v[20:23], v8 offset:34816
    v_mfma_f32_16x16x32_bf16 v[160:163], v[48:51], v[24:27], v[160:163]
    ds_read_b64_tr_b16 v[38:39], v13 offset:33792
    v_mfma_f32_16x16x32_bf16 v[164:167], v[52:55], v[24:27], v[164:167]
    ds_read_b64_tr_b16 v[40:41], v14 offset:32768
    v_mfma_f32_16x16x32_bf16 v[168:171], v[56:59], v[24:27], v[168:171]
    ds_read_b64_tr_b16 v[42:43], v14 offset:33792
    v_mfma_f32_16x16x32_bf16 v[172:175], v[60:63], v[24:27], v[172:175]
    ds_read_b128 v[24:27], v9 offset:32768
    v_mfma_f32_16x16x32_bf16 v[176:179], v[48:51], v[28:31], v[176:179]
    ds_read_b64_tr_b16 v[44:45], v15 offset:32768
    v_mfma_f32_16x16x32_bf16 v[180:183], v[52:55], v[28:31], v[180:183]
    ds_read_b64_tr_b16 v[46:47], v15 offset:33792
    v_mfma_f32_16x16x32_bf16 v[184:187], v[56:59], v[28:31], v[184:187]
    v_mfma_f32_16x16x32_bf16 v[188:191], v[60:63], v[28:31], v[188:191]
    ds_read_b128 v[28:31], v9 offset:34816
    s_waitcnt lgkmcnt(9)
    v_mfma_f32_16x16x32_bf16 v[128:131], v[32:35], v[16:19], v[128:131]
    ds_read_b64_tr_b16 v[48:49], v12 offset:40960
    s_waitcnt lgkmcnt(7)
    v_mfma_f32_16x16x32_bf16 v[132:135], v[36:39], v[16:19], v[132:135]
    ds_read_b64_tr_b16 v[50:51], v12 offset:41984
    s_waitcnt lgkmcnt(6)
    v_mfma_f32_16x16x32_bf16 v[136:139], v[40:43], v[16:19], v[136:139]
    ds_read_b64_tr_b16 v[52:53], v13 offset:40960
    s_waitcnt lgkmcnt(4)
    v_mfma_f32_16x16x32_bf16 v[140:143], v[44:47], v[16:19], v[140:143]
    ds_read_b128 v[16:19], v10 offset:32768
    v_mfma_f32_16x16x32_bf16 v[144:147], v[32:35], v[20:23], v[144:147]
    ds_read_b64_tr_b16 v[54:55], v13 offset:41984
    v_mfma_f32_16x16x32_bf16 v[148:151], v[36:39], v[20:23], v[148:151]
    ds_read_b64_tr_b16 v[56:57], v14 offset:40960
    v_mfma_f32_16x16x32_bf16 v[152:155], v[40:43], v[20:23], v[152:155]
    ds_read_b64_tr_b16 v[58:59], v14 offset:41984
    v_mfma_f32_16x16x32_bf16 v[156:159], v[44:47], v[20:23], v[156:159]
    ds_read_b128 v[20:23], v10 offset:34816
    v_mfma_f32_16x16x32_bf16 v[160:163], v[32:35], v[24:27], v[160:163]
    ds_read_b64_tr_b16 v[60:61], v15 offset:40960
    v_mfma_f32_16x16x32_bf16 v[164:167], v[36:39], v[24:27], v[164:167]
    ds_read_b64_tr_b16 v[62:63], v15 offset:41984
    v_mfma_f32_16x16x32_bf16 v[168:171], v[40:43], v[24:27], v[168:171]
    v_add_u32 v8, 0x10000, v8
    v_add_u32 v9, 0x10000, v9
    v_mfma_f32_16x16x32_bf16 v[172:175], v[44:47], v[24:27], v[172:175]
    ds_read_b128 v[24:27], v11 offset:32768
    s_waitcnt lgkmcnt(11)
    v_mfma_f32_16x16x32_bf16 v[176:179], v[32:35], v[28:31], v[176:179]
    v_add_u32 v12, 0x10000, v12
    ds_read_b64 v[192:193], v115 offset:0
    v_mfma_f32_16x16x32_bf16 v[180:183], v[36:39], v[28:31], v[180:183]
    v_add_u32 v13, 0x10000, v13
    ds_read_b64 v[194:195], v119 offset:0
    v_mfma_f32_16x16x32_bf16 v[184:187], v[40:43], v[28:31], v[184:187]
    v_add_u32 v14, 0x10000, v14
    v_add_u32 v15, 0x10000, v15
    v_mfma_f32_16x16x32_bf16 v[188:191], v[44:47], v[28:31], v[188:191]
    ds_read_b128 v[28:31], v11 offset:34816
    s_waitcnt lgkmcnt(10)
    v_mfma_f32_16x16x32_bf16 v[128:131], v[48:51], v[16:19], v[128:131]
    v_add_u32 v10, 0x10000, v10
    s_waitcnt lgkmcnt(9)
    v_mfma_f32_16x16x32_bf16 v[132:135], v[52:55], v[16:19], v[132:135]
    v_add_u32 v11, 0x10000, v11
    s_waitcnt lgkmcnt(7)
    v_mfma_f32_16x16x32_bf16 v[136:139], v[56:59], v[16:19], v[136:139]
    ds_read_b64 v[196:197], v120 offset:0
    s_waitcnt lgkmcnt(5)
    v_mfma_f32_16x16x32_bf16 v[140:143], v[60:63], v[16:19], v[140:143]
    s_waitcnt lgkmcnt(0)
    s_barrier
    ds_read_b128 v[16:19], v8 offset:0
    v_mfma_f32_16x16x32_bf16 v[144:147], v[48:51], v[20:23], v[144:147]
    ds_read_b64_tr_b16 v[32:33], v12 offset:0
    v_mfma_f32_16x16x32_bf16 v[148:151], v[52:55], v[20:23], v[148:151]
    ds_read_b64_tr_b16 v[34:35], v12 offset:1024
    v_mfma_f32_16x16x32_bf16 v[152:155], v[56:59], v[20:23], v[152:155]
    ds_read_b64_tr_b16 v[36:37], v13 offset:0
    v_mfma_f32_16x16x32_bf16 v[156:159], v[60:63], v[20:23], v[156:159]
    ds_read_b128 v[20:23], v8 offset:2048
    v_mfma_f32_16x16x32_bf16 v[160:163], v[48:51], v[24:27], v[160:163]
    ds_read_b64_tr_b16 v[38:39], v13 offset:1024
    v_mfma_f32_16x16x32_bf16 v[164:167], v[52:55], v[24:27], v[164:167]
    ds_read_b64_tr_b16 v[40:41], v14 offset:0
    v_mfma_f32_16x16x32_bf16 v[168:171], v[56:59], v[24:27], v[168:171]
    ds_read_b64_tr_b16 v[42:43], v14 offset:1024
    v_mfma_f32_16x16x32_bf16 v[172:175], v[60:63], v[24:27], v[172:175]
    ds_read_b128 v[24:27], v9 offset:0
    v_mfma_f32_16x16x32_bf16 v[176:179], v[48:51], v[28:31], v[176:179]
    ds_read_b64_tr_b16 v[44:45], v15 offset:0
    v_mfma_f32_16x16x32_bf16 v[180:183], v[52:55], v[28:31], v[180:183]
    ds_read_b64_tr_b16 v[46:47], v15 offset:1024
    v_mfma_f32_16x16x32_bf16 v[184:187], v[56:59], v[28:31], v[184:187]
    ds_read_b64 v[198:199], v121 offset:0
    v_mfma_f32_16x16x32_bf16 v[188:191], v[60:63], v[28:31], v[188:191]
    ds_read_b128 v[28:31], v9 offset:2048
    ds_read_b64 v[200:201], v115 offset:2048
    ds_read_b64 v[202:203], v119 offset:2048
    ds_read_b64 v[204:205], v120 offset:2048
    ds_read_b64 v[206:207], v121 offset:2048
    s_waitcnt lgkmcnt(14)
    v_mfma_f32_16x16x32_bf16 v[128:131], v[32:35], v[16:19], v[128:131]
    ds_read_b64_tr_b16 v[48:49], v12 offset:8192
    s_waitcnt lgkmcnt(12)
    v_mfma_f32_16x16x32_bf16 v[132:135], v[36:39], v[16:19], v[132:135]
    ds_read_b64_tr_b16 v[50:51], v12 offset:9216
    s_waitcnt lgkmcnt(11)
    v_mfma_f32_16x16x32_bf16 v[136:139], v[40:43], v[16:19], v[136:139]
    ds_read_b64_tr_b16 v[52:53], v13 offset:8192
    s_waitcnt lgkmcnt(9)
    v_mfma_f32_16x16x32_bf16 v[140:143], v[44:47], v[16:19], v[140:143]
    ds_read_b128 v[16:19], v10 offset:0
    v_mfma_f32_16x16x32_bf16 v[144:147], v[32:35], v[20:23], v[144:147]
    ds_read_b64_tr_b16 v[54:55], v13 offset:9216
    v_mfma_f32_16x16x32_bf16 v[148:151], v[36:39], v[20:23], v[148:151]
    ds_read_b64_tr_b16 v[56:57], v14 offset:8192
    v_mfma_f32_16x16x32_bf16 v[152:155], v[40:43], v[20:23], v[152:155]
    ds_read_b64_tr_b16 v[58:59], v14 offset:9216
    v_mfma_f32_16x16x32_bf16 v[156:159], v[44:47], v[20:23], v[156:159]
    ds_read_b128 v[20:23], v10 offset:2048
    v_mfma_f32_16x16x32_bf16 v[160:163], v[32:35], v[24:27], v[160:163]
    ds_read_b64_tr_b16 v[60:61], v15 offset:8192
    v_mfma_f32_16x16x32_bf16 v[164:167], v[36:39], v[24:27], v[164:167]
    ds_read_b64_tr_b16 v[62:63], v15 offset:9216
    v_mfma_f32_16x16x32_bf16 v[168:171], v[40:43], v[24:27], v[168:171]
    ds_read_b64 v[208:209], v116 offset:0
    v_mfma_f32_16x16x32_bf16 v[172:175], v[44:47], v[24:27], v[172:175]
    ds_read_b128 v[24:27], v11 offset:0
    s_waitcnt lgkmcnt(15)
    v_mfma_f32_16x16x32_bf16 v[176:179], v[32:35], v[28:31], v[176:179]
    ds_read_b64 v[210:211], v122 offset:0
    v_mfma_f32_16x16x32_bf16 v[180:183], v[36:39], v[28:31], v[180:183]
    ds_read_b64 v[212:213], v123 offset:0
    v_mfma_f32_16x16x32_bf16 v[184:187], v[40:43], v[28:31], v[184:187]
    ds_read_b64 v[214:215], v124 offset:0
    v_mfma_f32_16x16x32_bf16 v[188:191], v[44:47], v[28:31], v[188:191]
    ds_read_b128 v[28:31], v11 offset:2048
    s_waitcnt lgkmcnt(12)
    v_mfma_f32_16x16x32_bf16 v[128:131], v[48:51], v[16:19], v[128:131]
    ds_read_b64 v[216:217], v116 offset:2048
    s_waitcnt lgkmcnt(12)
    v_mfma_f32_16x16x32_bf16 v[132:135], v[52:55], v[16:19], v[132:135]
    ds_read_b64 v[218:219], v122 offset:2048
    s_waitcnt lgkmcnt(11)
    v_mfma_f32_16x16x32_bf16 v[136:139], v[56:59], v[16:19], v[136:139]
    ds_read_b64 v[220:221], v123 offset:2048
    s_waitcnt lgkmcnt(9)
    v_mfma_f32_16x16x32_bf16 v[140:143], v[60:63], v[16:19], v[140:143]
    s_waitcnt lgkmcnt(0)
    s_barrier
    ds_read_b128 v[16:19], v8 offset:32768
    v_mfma_f32_16x16x32_bf16 v[144:147], v[48:51], v[20:23], v[144:147]
    ds_read_b64_tr_b16 v[32:33], v12 offset:32768
    v_mfma_f32_16x16x32_bf16 v[148:151], v[52:55], v[20:23], v[148:151]
    ds_read_b64_tr_b16 v[34:35], v12 offset:33792
    v_mfma_f32_16x16x32_bf16 v[152:155], v[56:59], v[20:23], v[152:155]
    ds_read_b64_tr_b16 v[36:37], v13 offset:32768
    v_mfma_f32_16x16x32_bf16 v[156:159], v[60:63], v[20:23], v[156:159]
    ds_read_b128 v[20:23], v8 offset:34816
    v_mfma_f32_16x16x32_bf16 v[160:163], v[48:51], v[24:27], v[160:163]
    ds_read_b64_tr_b16 v[38:39], v13 offset:33792
    v_mfma_f32_16x16x32_bf16 v[164:167], v[52:55], v[24:27], v[164:167]
    ds_read_b64_tr_b16 v[40:41], v14 offset:32768
    v_mfma_f32_16x16x32_bf16 v[168:171], v[56:59], v[24:27], v[168:171]
    ds_read_b64_tr_b16 v[42:43], v14 offset:33792
    v_mfma_f32_16x16x32_bf16 v[172:175], v[60:63], v[24:27], v[172:175]
    ds_read_b128 v[24:27], v9 offset:32768
    v_mfma_f32_16x16x32_bf16 v[176:179], v[48:51], v[28:31], v[176:179]
    ds_read_b64_tr_b16 v[44:45], v15 offset:32768
    v_mfma_f32_16x16x32_bf16 v[180:183], v[52:55], v[28:31], v[180:183]
    ds_read_b64_tr_b16 v[46:47], v15 offset:33792
    v_mfma_f32_16x16x32_bf16 v[184:187], v[56:59], v[28:31], v[184:187]
    ds_read_b64 v[222:223], v124 offset:2048
    v_mfma_f32_16x16x32_bf16 v[188:191], v[60:63], v[28:31], v[188:191]
    ds_read_b128 v[28:31], v9 offset:34816
    s_waitcnt lgkmcnt(10)
    v_mfma_f32_16x16x32_bf16 v[128:131], v[32:35], v[16:19], v[128:131]
    ds_read_b64_tr_b16 v[48:49], v12 offset:40960
    s_waitcnt lgkmcnt(8)
    v_mfma_f32_16x16x32_bf16 v[132:135], v[36:39], v[16:19], v[132:135]
    ds_read_b64_tr_b16 v[50:51], v12 offset:41984
    s_waitcnt lgkmcnt(7)
    v_mfma_f32_16x16x32_bf16 v[136:139], v[40:43], v[16:19], v[136:139]
    ds_read_b64_tr_b16 v[52:53], v13 offset:40960
    s_waitcnt lgkmcnt(5)
    v_mfma_f32_16x16x32_bf16 v[140:143], v[44:47], v[16:19], v[140:143]
    ds_read_b128 v[16:19], v10 offset:32768
    v_mfma_f32_16x16x32_bf16 v[144:147], v[32:35], v[20:23], v[144:147]
    ds_read_b64_tr_b16 v[54:55], v13 offset:41984
    v_mfma_f32_16x16x32_bf16 v[148:151], v[36:39], v[20:23], v[148:151]
    ds_read_b64_tr_b16 v[56:57], v14 offset:40960
    v_mfma_f32_16x16x32_bf16 v[152:155], v[40:43], v[20:23], v[152:155]
    ds_read_b64_tr_b16 v[58:59], v14 offset:41984
    v_mfma_f32_16x16x32_bf16 v[156:159], v[44:47], v[20:23], v[156:159]
    ds_read_b128 v[20:23], v10 offset:34816
    v_mfma_f32_16x16x32_bf16 v[160:163], v[32:35], v[24:27], v[160:163]
    ds_read_b64_tr_b16 v[60:61], v15 offset:40960
    v_mfma_f32_16x16x32_bf16 v[164:167], v[36:39], v[24:27], v[164:167]
    ds_read_b64_tr_b16 v[62:63], v15 offset:41984
    v_mfma_f32_16x16x32_bf16 v[168:171], v[40:43], v[24:27], v[168:171]
    v_mfma_f32_16x16x32_bf16 v[172:175], v[44:47], v[24:27], v[172:175]
    ds_read_b128 v[24:27], v11 offset:32768
    s_waitcnt lgkmcnt(11)
    v_mfma_f32_16x16x32_bf16 v[176:179], v[32:35], v[28:31], v[176:179]
    v_mfma_f32_16x16x32_bf16 v[180:183], v[36:39], v[28:31], v[180:183]
    v_mfma_f32_16x16x32_bf16 v[184:187], v[40:43], v[28:31], v[184:187]
    v_mfma_f32_16x16x32_bf16 v[188:191], v[44:47], v[28:31], v[188:191]
    ds_read_b128 v[28:31], v11 offset:34816
    s_waitcnt lgkmcnt(8)
    v_mfma_f32_16x16x32_bf16 v[128:131], v[48:51], v[16:19], v[128:131]
    v_add_u32 v8, 0xffff0000, v8
    s_waitcnt lgkmcnt(7)
    v_mfma_f32_16x16x32_bf16 v[132:135], v[52:55], v[16:19], v[132:135]
    v_add_u32 v9, 0xffff0000, v9
    s_waitcnt lgkmcnt(5)
    v_mfma_f32_16x16x32_bf16 v[136:139], v[56:59], v[16:19], v[136:139]
    v_add_u32 v10, 0xffff0000, v10
    s_waitcnt lgkmcnt(2)
    v_mfma_f32_16x16x32_bf16 v[140:143], v[60:63], v[16:19], v[140:143]
    v_add_u32 v11, 0xffff0000, v11
    v_add_u32 v12, 0xffff0000, v12
    v_mfma_f32_16x16x32_bf16 v[144:147], v[48:51], v[20:23], v[144:147]
    v_add_u32 v13, 0xffff0000, v13
    v_add_u32 v14, 0xffff0000, v14
    v_mfma_f32_16x16x32_bf16 v[148:151], v[52:55], v[20:23], v[148:151]
    v_add_u32 v15, 0xffff0000, v15
    v_xor_b32 v8, s52, v8
    v_mfma_f32_16x16x32_bf16 v[152:155], v[56:59], v[20:23], v[152:155]
    v_xor_b32 v9, s52, v9
    v_xor_b32 v10, s52, v10
    v_mfma_f32_16x16x32_bf16 v[156:159], v[60:63], v[20:23], v[156:159]
    v_xor_b32 v11, s52, v11
    s_waitcnt lgkmcnt(1)
    v_mfma_f32_16x16x32_bf16 v[160:163], v[48:51], v[24:27], v[160:163]
    v_xor_b32 v119, s53, v117
    v_xor_b32 v121, s53, v118
    v_cvt_pk_bf16_f32 v64, v128, v129
    v_mfma_f32_16x16x32_bf16 v[164:167], v[52:55], v[24:27], v[164:167]
    v_xor_b32 v120, 0x400, v119
    v_xor_b32 v122, 0x400, v121
    v_cvt_pk_bf16_f32 v65, v130, v131
    v_mfma_f32_16x16x32_bf16 v[168:171], v[56:59], v[24:27], v[168:171]
    v_cvt_pk_bf16_f32 v66, v132, v133
    v_cvt_pk_bf16_f32 v67, v134, v135
    v_cvt_pk_bf16_f32 v68, v136, v137
    v_mfma_f32_16x16x32_bf16 v[172:175], v[60:63], v[24:27], v[172:175]
    v_cvt_pk_bf16_f32 v69, v138, v139
    v_cvt_pk_bf16_f32 v70, v140, v141
    s_waitcnt lgkmcnt(0)
    v_mfma_f32_16x16x32_bf16 v[176:179], v[48:51], v[28:31], v[176:179]
    v_cvt_pk_bf16_f32 v71, v142, v143
    v_cvt_pk_bf16_f32 v72, v144, v145
    v_cvt_pk_bf16_f32 v73, v146, v147
    v_mfma_f32_16x16x32_bf16 v[180:183], v[52:55], v[28:31], v[180:183]
    v_cvt_pk_bf16_f32 v74, v148, v149
    v_cvt_pk_bf16_f32 v75, v150, v151
    v_cvt_pk_bf16_f32 v76, v152, v153
    v_mfma_f32_16x16x32_bf16 v[184:187], v[56:59], v[28:31], v[184:187]
    v_cvt_pk_bf16_f32 v77, v154, v155
    v_cvt_pk_bf16_f32 v78, v156, v157
    v_cvt_pk_bf16_f32 v79, v158, v159
    v_mfma_f32_16x16x32_bf16 v[188:191], v[60:63], v[28:31], v[188:191]
    v_mfma_f32_16x16x32_bf16 v[224:227], v[192:195], v[64:67], 0
    v_cvt_pk_bf16_f32 v80, v160, v161
    v_cvt_pk_bf16_f32 v81, v162, v163
    v_mfma_f32_16x16x32_bf16 v[228:231], v[192:195], v[72:75], 0
    v_cvt_pk_bf16_f32 v82, v164, v165
    v_cvt_pk_bf16_f32 v83, v166, v167
    v_mfma_f32_16x16x32_bf16 v[232:235], v[200:203], v[64:67], 0
    v_cvt_pk_bf16_f32 v84, v168, v169
    v_cvt_pk_bf16_f32 v85, v170, v171
    v_mfma_f32_16x16x32_bf16 v[236:239], v[200:203], v[72:75], 0
    v_cvt_pk_bf16_f32 v86, v172, v173
    v_cvt_pk_bf16_f32 v87, v174, v175
    v_mfma_f32_16x16x32_bf16 v[224:227], v[196:199], v[68:71], v[224:227]
    v_cvt_pk_bf16_f32 v88, v176, v177
    v_cvt_pk_bf16_f32 v89, v178, v179
    v_mfma_f32_16x16x32_bf16 v[228:231], v[196:199], v[76:79], v[228:231]
    v_cvt_pk_bf16_f32 v90, v180, v181
    v_cvt_pk_bf16_f32 v91, v182, v183
    v_mfma_f32_16x16x32_bf16 v[232:235], v[204:207], v[68:71], v[232:235]
    v_cvt_pk_bf16_f32 v92, v184, v185
    v_cvt_pk_bf16_f32 v93, v186, v187
    v_mfma_f32_16x16x32_bf16 v[236:239], v[204:207], v[76:79], v[236:239]
    v_cvt_pk_bf16_f32 v94, v188, v189
    v_cvt_pk_bf16_f32 v95, v190, v191
    ds_write_b128 v125, v[224:227] offset:0
    ds_write_b128 v125, v[228:231] offset:1024
    s_nop 0
    ds_write_b128 v125, v[232:235] offset:2048
    s_nop 1
    ds_write_b128 v125, v[236:239] offset:3072
    ds_write_b64 v125, v[112:113] offset:4096
    s_mov_b32 s44, 100000
L_spoll:
    ds_read_b64 v[2:3], v126 offset:4096
    s_sub_u32 s44, s44, 1
    s_cmp_eq_u32 s44, 0
    s_waitcnt lgkmcnt(0)
    s_cbranch_scc1 L_sgo
    v_cmp_ne_u64 vcc, v[2:3], v[112:113]
    s_cbranch_vccnz L_spoll
L_sgo:
    ds_read_b128 v[192:195], v126 offset:0
    ds_read_b128 v[196:199], v126 offset:1024
    ds_read_b128 v[200:203], v126 offset:2048
    ds_read_b128 v[204:207], v126 offset:3072
    s_waitcnt lgkmcnt(3)
    v_mfma_f32_16x16x32_bf16 v[240:243], v[208:211], v[80:83], v[192:195]
    s_waitcnt lgkmcnt(2)
    v_mfma_f32_16x16x32_bf16 v[244:247], v[208:211], v[88:91], v[196:199]
    s_waitcnt lgkmcnt(1)
    v_mfma_f32_16x16x32_bf16 v[248:251], v[216:219], v[80:83], v[200:203]
    s_waitcnt lgkmcnt(0)
    v_mfma_f32_16x16x32_bf16 v[252:255], v[216:219], v[88:91], v[204:207]
    v_mfma_f32_16x16x32_bf16 v[240:243], v[212:215], v[84:87], v[240:243]
    v_mfma_f32_16x16x32_bf16 v[244:247], v[212:215], v[92:95], v[244:247]
    v_mfma_f32_16x16x32_bf16 v[248:251], v[220:223], v[84:87], v[248:251]
    v_mfma_f32_16x16x32_bf16 v[252:255], v[220:223], v[92:95], v[252:255]
    s_nop 4
    v_max3_f32 v1, v240, v241, v242
    s_nop 0
    v_max3_f32 v1, v1, v243, v248
    v_max3_f32 v1, v1, v249, v250
    v_max_f32 v1, v1, v251
    v_max3_f32 v3, v244, v245, v246
    v_max3_f32 v3, v3, v247, v252
    v_max3_f32 v3, v3, v253, v254
    v_max_f32 v3, v3, v255
    v_mov_b32 v2, v1
    v_mov_b32 v4, v3
    s_nop 0
    v_permlane16_swap_b32 v1, v2
    v_permlane16_swap_b32 v3, v4
    v_max_f32 v1, v1, v2
    v_max_f32 v3, v3, v4
    v_mov_b32 v2, v1
    v_mov_b32 v4, v3
    s_nop 0
    v_permlane32_swap_b32 v1, v2
    v_permlane32_swap_b32 v3, v4
    v_max_f32 v1, v1, v2
    v_max_f32 v3, v3, v4
    v_mul_f32 v1, s50, v1
    v_mul_f32 v3, s50, v3
    v_fma_f32 v240, v240, s50, -v1
    v_fma_f32 v241, v241, s50, -v1
    v_fma_f32 v242, v242, s50, -v1
    v_fma_f32 v243, v243, s50, -v1
    v_fma_f32 v248, v248, s50, -v1
    v_fma_f32 v249, v249, s50, -v1
    v_fma_f32 v250, v250, s50, -v1
    v_fma_f32 v251, v251, s50, -v1
    v_fma_f32 v244, v244, s50, -v3
    v_fma_f32 v245, v245, s50, -v3
    v_fma_f32 v246, v246, s50, -v3
    v_fma_f32 v247, v247, s50, -v3
    v_fma_f32 v252, v252, s50, -v3
    v_fma_f32 v253, v253, s50, -v3
    v_fma_f32 v254, v254, s50, -v3
    v_fma_f32 v255, v255, s50, -v3
    v_exp_f32 v240, v240
    v_exp_f32 v241, v241
    v_exp_f32 v242, v242
    v_exp_f32 v243, v243
    v_exp_f32 v248, v248
    v_exp_f32 v249, v249
    v_exp_f32 v250, v250
    v_exp_f32 v251, v251
    v_exp_f32 v244, v244
    v_exp_f32 v245, v245
    v_exp_f32 v246, v246
    v_exp_f32 v247, v247
    v_exp_f32 v252, v252
    v_exp_f32 v253, v253
    v_exp_f32 v254, v254
    v_exp_f32 v255, v255
    v_add_f32 v1, v240, v241
    v_add_f32 v2, v242, v243
    v_add_f32 v1, v1, v248
    v_add_f32 v2, v2, v249
    v_add_f32 v1, v1, v250
    v_add_f32 v2, v2, v251
    v_add_f32 v1, v1, v2
    v_add_f32 v3, v244, v245
    v_add_f32 v4, v246, v247
    v_add_f32 v3, v3, v252
    v_add_f32 v4, v4, v253
    v_add_f32 v3, v3, v254
    v_add_f32 v4, v4, v255
    v_add_f32 v3, v3, v4
    v_mov_b32 v2, v1
    v_mov_b32 v4, v3
    s_nop 0
    v_permlane16_swap_b32 v1, v2
    v_permlane16_swap_b32 v3, v4
    v_add_f32 v1, v1, v2
    v_add_f32 v3, v3, v4
    v_mov_b32 v2, v1
    v_mov_b32 v4, v3
    s_nop 0
    v_permlane32_swap_b32 v1, v2
    v_permlane32_swap_b32 v3, v4
    v_add_f32 v1, v1, v2
    v_add_f32 v3, v3, v4
    v_rcp_f32 v1, v1
    v_rcp_f32 v3, v3
    v_mul_f32 v240, v240, v1
    v_mul_f32 v241, v241, v1
    v_mul_f32 v242, v242, v1
    v_mul_f32 v243, v243, v1
    v_mul_f32 v248, v248, v1
    v_mul_f32 v249, v249, v1
    v_mul_f32 v250, v250, v1
    v_mul_f32 v251, v251, v1
    v_cvt_pk_bf16_f32 v96, v240, v241
    v_cvt_pk_bf16_f32 v97, v242, v243
    v_cvt_pk_bf16_f32 v98, v248, v249
    v_cvt_pk_bf16_f32 v99, v250, v251
    buffer_store_dwordx4 v[96:99], v118, s[28:31], s49 offen offset:0 sc1
    v_mul_f32 v244, v244, v3
    v_mul_f32 v245, v245, v3
    v_mul_f32 v246, v246, v3
    v_mul_f32 v247, v247, v3
    v_mul_f32 v252, v252, v3
    v_mul_f32 v253, v253, v3
    v_mul_f32 v254, v254, v3
    v_mul_f32 v255, v255, v3
    v_cvt_pk_bf16_f32 v100, v244, v245
    v_cvt_pk_bf16_f32 v101, v246, v247
    v_cvt_pk_bf16_f32 v102, v252, v253
    v_cvt_pk_bf16_f32 v103, v254, v255
    buffer_store_dwordx4 v[100:103], v118, s[28:31], s49 offen offset:1024 sc1
    s_barrier
    ds_read_b64_tr_b16 v[32:33], v12 offset:0
    ds_read_b64_tr_b16 v[34:35], v12 offset:1024
    ds_read_b64_tr_b16 v[36:37], v13 offset:0
    ds_read_b128 v[16:19], v8 offset:0
    ds_read_b64_tr_b16 v[38:39], v13 offset:1024
    ds_read_b64_tr_b16 v[40:41], v14 offset:0
    ds_read_b64_tr_b16 v[42:43], v14 offset:1024
    ds_read_b128 v[20:23], v8 offset:2048
    ds_read_b64_tr_b16 v[44:45], v15 offset:0
    ds_read_b64_tr_b16 v[46:47], v15 offset:1024
    ds_read_b128 v[24:27], v9 offset:0
    ds_read_b128 v[28:31], v9 offset:2048
    ds_write_b128 v127, v[96:99] offset:0
    ds_write_b128 v127, v[100:103] offset:1024
    s_waitcnt lgkmcnt(10)
    v_mfma_f32_16x16x32_bf16 v[128:131], v[16:19], v[32:35], 0
    ds_read_b64_tr_b16 v[48:49], v12 offset:8192
    s_waitcnt lgkmcnt(10)
    v_mfma_f32_16x16x32_bf16 v[132:135], v[16:19], v[36:39], 0
    ds_read_b64_tr_b16 v[50:51], v12 offset:9216
    s_waitcnt lgkmcnt(9)
    v_mfma_f32_16x16x32_bf16 v[136:139], v[16:19], v[40:43], 0
    ds_read_b64_tr_b16 v[52:53], v13 offset:8192
    s_waitcnt lgkmcnt(7)
    v_mfma_f32_16x16x32_bf16 v[140:143], v[16:19], v[44:47], 0
    ds_read_b128 v[16:19], v10 offset:0
    v_mfma_f32_16x16x32_bf16 v[144:147], v[20:23], v[32:35], 0
    ds_read_b64_tr_b16 v[54:55], v13 offset:9216
    v_mfma_f32_16x16x32_bf16 v[148:151], v[20:23], v[36:39], 0
    ds_read_b64_tr_b16 v[56:57], v14 offset:8192
    v_mfma_f32_16x16x32_bf16 v[152:155], v[20:23], v[40:43], 0
    ds_read_b64_tr_b16 v[58:59], v14 offset:9216
    v_mfma_f32_16x16x32_bf16 v[156:159], v[20:23], v[44:47], 0
    ds_read_b128 v[20:23], v10 offset:2048
    s_waitcnt lgkmcnt(11)
    v_mfma_f32_16x16x32_bf16 v[160:163], v[24:27], v[32:35], 0
    ds_read_b64_tr_b16 v[60:61], v15 offset:8192
    s_waitcnt vmcnt(0)
    buffer_store_dwordx2 v[112:113], v114, s[28:31], s60 offen sc1
    v_mfma_f32_16x16x32_bf16 v[164:167], v[24:27], v[36:39], 0
    ds_read_b64_tr_b16 v[62:63], v15 offset:9216
    v_mfma_f32_16x16x32_bf16 v[168:171], v[24:27], v[40:43], 0
    v_mfma_f32_16x16x32_bf16 v[172:175], v[24:27], v[44:47], 0
    ds_read_b128 v[24:27], v11 offset:0
    s_waitcnt lgkmcnt(13)
    v_mfma_f32_16x16x32_bf16 v[176:179], v[28:31], v[32:35], 0
    v_mfma_f32_16x16x32_bf16 v[180:183], v[28:31], v[36:39], 0
    v_mfma_f32_16x16x32_bf16 v[184:187], v[28:31], v[40:43], 0
    v_mfma_f32_16x16x32_bf16 v[188:191], v[28:31], v[44:47], 0
    ds_read_b128 v[28:31], v11 offset:2048
    s_waitcnt lgkmcnt(8)
    v_mfma_f32_16x16x32_bf16 v[128:131], v[16:19], v[48:51], v[128:131]
    s_waitcnt lgkmcnt(7)
    v_mfma_f32_16x16x32_bf16 v[132:135], v[16:19], v[52:55], v[132:135]
    s_waitcnt lgkmcnt(5)
    v_mfma_f32_16x16x32_bf16 v[136:139], v[16:19], v[56:59], v[136:139]
    s_waitcnt lgkmcnt(2)
    v_mfma_f32_16x16x32_bf16 v[140:143], v[16:19], v[60:63], v[140:143]
    s_waitcnt lgkmcnt(0)
    s_barrier
    ds_read_b128 v[16:19], v8 offset:32768
    v_mfma_f32_16x16x32_bf16 v[144:147], v[20:23], v[48:51], v[144:147]
    ds_read_b64_tr_b16 v[32:33], v12 offset:32768
    v_mfma_f32_16x16x32_bf16 v[148:151], v[20:23], v[52:55], v[148:151]
    ds_read_b64_tr_b16 v[34:35], v12 offset:33792
    v_mfma_f32_16x16x32_bf16 v[152:155], v[20:23], v[56:59], v[152:155]
    ds_read_b64_tr_b16 v[36:37], v13 offset:32768
    v_mfma_f32_16x16x32_bf16 v[156:159], v[20:23], v[60:63], v[156:159]
    ds_read_b128 v[20:23], v8 offset:34816
    v_mfma_f32_16x16x32_bf16 v[160:163], v[24:27], v[48:51], v[160:163]
    ds_read_b64_tr_b16 v[38:39], v13 offset:33792
    v_mfma_f32_16x16x32_bf16 v[164:167], v[24:27], v[52:55], v[164:167]
    ds_read_b64_tr_b16 v[40:41], v14 offset:32768
    v_mfma_f32_16x16x32_bf16 v[168:171], v[24:27], v[56:59], v[168:171]
    ds_read_b64_tr_b16 v[42:43], v14 offset:33792
    v_mfma_f32_16x16x32_bf16 v[172:175], v[24:27], v[60:63], v[172:175]
    ds_read_b128 v[24:27], v9 offset:32768
    v_mfma_f32_16x16x32_bf16 v[176:179], v[28:31], v[48:51], v[176:179]
    ds_read_b64_tr_b16 v[44:45], v15 offset:32768
    v_mfma_f32_16x16x32_bf16 v[180:183], v[28:31], v[52:55], v[180:183]
    ds_read_b64_tr_b16 v[46:47], v15 offset:33792
    v_mfma_f32_16x16x32_bf16 v[184:187], v[28:31], v[56:59], v[184:187]
    v_mfma_f32_16x16x32_bf16 v[188:191], v[28:31], v[60:63], v[188:191]
    ds_read_b128 v[28:31], v9 offset:34816
    s_waitcnt lgkmcnt(9)
    v_mfma_f32_16x16x32_bf16 v[128:131], v[16:19], v[32:35], v[128:131]
    ds_read_b64_tr_b16 v[48:49], v12 offset:40960
    s_waitcnt lgkmcnt(7)
    v_mfma_f32_16x16x32_bf16 v[132:135], v[16:19], v[36:39], v[132:135]
    ds_read_b64_tr_b16 v[50:51], v12 offset:41984
    s_waitcnt lgkmcnt(6)
    v_mfma_f32_16x16x32_bf16 v[136:139], v[16:19], v[40:43], v[136:139]
    ds_read_b64_tr_b16 v[52:53], v13 offset:40960
    s_waitcnt lgkmcnt(4)
    v_mfma_f32_16x16x32_bf16 v[140:143], v[16:19], v[44:47], v[140:143]
    ds_read_b128 v[16:19], v10 offset:32768
    v_mfma_f32_16x16x32_bf16 v[144:147], v[20:23], v[32:35], v[144:147]
    ds_read_b64_tr_b16 v[54:55], v13 offset:41984
    v_mfma_f32_16x16x32_bf16 v[148:151], v[20:23], v[36:39], v[148:151]
    ds_read_b64_tr_b16 v[56:57], v14 offset:40960
    v_mfma_f32_16x16x32_bf16 v[152:155], v[20:23], v[40:43], v[152:155]
    ds_read_b64_tr_b16 v[58:59], v14 offset:41984
    v_mfma_f32_16x16x32_bf16 v[156:159], v[20:23], v[44:47], v[156:159]
    ds_read_b128 v[20:23], v10 offset:34816
    v_mfma_f32_16x16x32_bf16 v[160:163], v[24:27], v[32:35], v[160:163]
    ds_read_b64_tr_b16 v[60:61], v15 offset:40960
    v_mfma_f32_16x16x32_bf16 v[164:167], v[24:27], v[36:39], v[164:167]
    ds_read_b64_tr_b16 v[62:63], v15 offset:41984
    v_mfma_f32_16x16x32_bf16 v[168:171], v[24:27], v[40:43], v[168:171]
    v_add_u32 v8, 0x10000, v8
    v_add_u32 v9, 0x10000, v9
    v_mfma_f32_16x16x32_bf16 v[172:175], v[24:27], v[44:47], v[172:175]
    ds_read_b128 v[24:27], v11 offset:32768
    s_waitcnt lgkmcnt(11)
    v_mfma_f32_16x16x32_bf16 v[176:179], v[28:31], v[32:35], v[176:179]
    v_add_u32 v12, 0x10000, v12
    v_mfma_f32_16x16x32_bf16 v[180:183], v[28:31], v[36:39], v[180:183]
    v_add_u32 v13, 0x10000, v13
    v_mfma_f32_16x16x32_bf16 v[184:187], v[28:31], v[40:43], v[184:187]
    v_add_u32 v14, 0x10000, v14
    v_add_u32 v15, 0x10000, v15
    v_mfma_f32_16x16x32_bf16 v[188:191], v[28:31], v[44:47], v[188:191]
    ds_read_b128 v[28:31], v11 offset:34816
    s_waitcnt lgkmcnt(8)
    v_mfma_f32_16x16x32_bf16 v[128:131], v[16:19], v[48:51], v[128:131]
    v_add_u32 v10, 0x10000, v10
    s_waitcnt lgkmcnt(7)
    v_mfma_f32_16x16x32_bf16 v[132:135], v[16:19], v[52:55], v[132:135]
    v_add_u32 v11, 0x10000, v11
    s_waitcnt lgkmcnt(5)
    v_mfma_f32_16x16x32_bf16 v[136:139], v[16:19], v[56:59], v[136:139]
    s_waitcnt lgkmcnt(2)
    v_mfma_f32_16x16x32_bf16 v[140:143], v[16:19], v[60:63], v[140:143]
    s_waitcnt lgkmcnt(0)
    s_barrier
    ds_read_b128 v[16:19], v8 offset:0
    v_mfma_f32_16x16x32_bf16 v[144:147], v[20:23], v[48:51], v[144:147]
    ds_read_b64_tr_b16 v[32:33], v12 offset:0
    v_mfma_f32_16x16x32_bf16 v[148:151], v[20:23], v[52:55], v[148:151]
    ds_read_b64_tr_b16 v[34:35], v12 offset:1024
    v_mfma_f32_16x16x32_bf16 v[152:155], v[20:23], v[56:59], v[152:155]
    ds_read_b64_tr_b16 v[36:37], v13 offset:0
    v_mfma_f32_16x16x32_bf16 v[156:159], v[20:23], v[60:63], v[156:159]
    ds_read_b128 v[20:23], v8 offset:2048
    v_mfma_f32_16x16x32_bf16 v[160:163], v[24:27], v[48:51], v[160:163]
    ds_read_b64_tr_b16 v[38:39], v13 offset:1024
    v_mfma_f32_16x16x32_bf16 v[164:167], v[24:27], v[52:55], v[164:167]
    ds_read_b64_tr_b16 v[40:41], v14 offset:0
    v_mfma_f32_16x16x32_bf16 v[168:171], v[24:27], v[56:59], v[168:171]
    ds_read_b64_tr_b16 v[42:43], v14 offset:1024
    v_cvt_pk_bf16_f32 v64, v128, v129
    v_cvt_pk_bf16_f32 v65, v130, v131
    v_mfma_f32_16x16x32_bf16 v[172:175], v[24:27], v[60:63], v[172:175]
    ds_read_b128 v[24:27], v9 offset:0
    v_cvt_pk_bf16_f32 v66, v144, v145
    v_mfma_f32_16x16x32_bf16 v[176:179], v[28:31], v[48:51], v[176:179]
    ds_read_b64_tr_b16 v[44:45], v15 offset:0
    v_cvt_pk_bf16_f32 v67, v146, v147
    v_cvt_pk_bf16_f32 v68, v132, v133
    v_mfma_f32_16x16x32_bf16 v[180:183], v[28:31], v[52:55], v[180:183]
    ds_read_b64_tr_b16 v[46:47], v15 offset:1024
    v_cvt_pk_bf16_f32 v69, v134, v135
    v_cvt_pk_bf16_f32 v70, v148, v149
    v_mfma_f32_16x16x32_bf16 v[184:187], v[28:31], v[56:59], v[184:187]
    v_cvt_pk_bf16_f32 v71, v150, v151
    v_cvt_pk_bf16_f32 v72, v136, v137
    v_cvt_pk_bf16_f32 v73, v138, v139
    v_mfma_f32_16x16x32_bf16 v[188:191], v[28:31], v[60:63], v[188:191]
    ds_read_b128 v[28:31], v9 offset:2048
    v_cvt_pk_bf16_f32 v74, v152, v153
    v_cvt_pk_bf16_f32 v75, v154, v155
    v_cvt_pk_bf16_f32 v76, v140, v141
    v_cvt_pk_bf16_f32 v77, v142, v143
    v_cvt_pk_bf16_f32 v78, v156, v157
    v_cvt_pk_bf16_f32 v79, v158, v159
    v_cvt_pk_bf16_f32 v80, v160, v161
    v_cvt_pk_bf16_f32 v81, v162, v163
    v_cvt_pk_bf16_f32 v82, v176, v177
    v_cvt_pk_bf16_f32 v83, v178, v179
    v_cvt_pk_bf16_f32 v84, v164, v165
    v_cvt_pk_bf16_f32 v85, v166, v167
    v_cvt_pk_bf16_f32 v86, v180, v181
    v_cvt_pk_bf16_f32 v87, v182, v183
    v_cvt_pk_bf16_f32 v88, v168, v169
    v_cvt_pk_bf16_f32 v89, v170, v171
    v_cvt_pk_bf16_f32 v90, v184, v185
    v_cvt_pk_bf16_f32 v91, v186, v187
    v_cvt_pk_bf16_f32 v92, v172, v173
    v_cvt_pk_bf16_f32 v93, v174, v175
    v_cvt_pk_bf16_f32 v94, v188, v189
    v_cvt_pk_bf16_f32 v95, v190, v191
    s_waitcnt lgkmcnt(9)
    v_mfma_f32_16x16x32_bf16 v[128:131], v[16:19], v[32:35], 0
    ds_read_b64_tr_b16 v[48:49], v12 offset:8192
    s_waitcnt lgkmcnt(7)
    v_mfma_f32_16x16x32_bf16 v[132:135], v[16:19], v[36:39], 0
    ds_read_b64_tr_b16 v[50:51], v12 offset:9216
    s_waitcnt lgkmcnt(6)
    v_mfma_f32_16x16x32_bf16 v[136:139], v[16:19], v[40:43], 0
    ds_read_b64_tr_b16 v[52:53], v13 offset:8192
    s_waitcnt lgkmcnt(4)
    v_mfma_f32_16x16x32_bf16 v[140:143], v[16:19], v[44:47], 0
    ds_read_b128 v[16:19], v10 offset:0
    v_mfma_f32_16x16x32_bf16 v[144:147], v[20:23], v[32:35], 0
    ds_read_b64_tr_b16 v[54:55], v13 offset:9216
    v_mfma_f32_16x16x32_bf16 v[148:151], v[20:23], v[36:39], 0
    ds_read_b64_tr_b16 v[56:57], v14 offset:8192
    v_mfma_f32_16x16x32_bf16 v[152:155], v[20:23], v[40:43], 0
    ds_read_b64_tr_b16 v[58:59], v14 offset:9216
    v_mfma_f32_16x16x32_bf16 v[156:159], v[20:23], v[44:47], 0
    ds_read_b128 v[20:23], v10 offset:2048
    v_mfma_f32_16x16x32_bf16 v[160:163], v[24:27], v[32:35], 0
    ds_read_b64_tr_b16 v[60:61], v15 offset:8192
    v_mfma_f32_16x16x32_bf16 v[164:167], v[24:27], v[36:39], 0
    ds_read_b64_tr_b16 v[62:63], v15 offset:9216
    v_mfma_f32_16x16x32_bf16 v[168:171], v[24:27], v[40:43], 0
    v_mfma_f32_16x16x32_bf16 v[172:175], v[24:27], v[44:47], 0
    ds_read_b128 v[24:27], v11 offset:0
    s_waitcnt lgkmcnt(11)
    v_mfma_f32_16x16x32_bf16 v[176:179], v[28:31], v[32:35], 0
    v_mfma_f32_16x16x32_bf16 v[180:183], v[28:31], v[36:39], 0
    v_mfma_f32_16x16x32_bf16 v[184:187], v[28:31], v[40:43], 0
    v_mfma_f32_16x16x32_bf16 v[188:191], v[28:31], v[44:47], 0
    ds_read_b128 v[28:31], v11 offset:2048
    s_waitcnt lgkmcnt(8)
    v_mfma_f32_16x16x32_bf16 v[128:131], v[16:19], v[48:51], v[128:131]
    s_waitcnt lgkmcnt(7)
    v_mfma_f32_16x16x32_bf16 v[132:135], v[16:19], v[52:55], v[132:135]
    s_waitcnt lgkmcnt(5)
    v_mfma_f32_16x16x32_bf16 v[136:139], v[16:19], v[56:59], v[136:139]
    s_waitcnt lgkmcnt(2)
    v_mfma_f32_16x16x32_bf16 v[140:143], v[16:19], v[60:63], v[140:143]
    s_waitcnt lgkmcnt(0)
    s_barrier
    ds_read_b128 v[16:19], v8 offset:32768
    v_mfma_f32_16x16x32_bf16 v[144:147], v[20:23], v[48:51], v[144:147]
    ds_read_b64_tr_b16 v[32:33], v12 offset:32768
    v_mfma_f32_16x16x32_bf16 v[148:151], v[20:23], v[52:55], v[148:151]
    ds_read_b64_tr_b16 v[34:35], v12 offset:33792
    v_mfma_f32_16x16x32_bf16 v[152:155], v[20:23], v[56:59], v[152:155]
    ds_read_b64_tr_b16 v[36:37], v13 offset:32768
    v_mfma_f32_16x16x32_bf16 v[156:159], v[20:23], v[60:63], v[156:159]
    ds_read_b128 v[20:23], v8 offset:34816
    v_mfma_f32_16x16x32_bf16 v[160:163], v[24:27], v[48:51], v[160:163]
    ds_read_b64_tr_b16 v[38:39], v13 offset:33792
    v_mfma_f32_16x16x32_bf16 v[164:167], v[24:27], v[52:55], v[164:167]
    ds_read_b64_tr_b16 v[40:41], v14 offset:32768
    v_mfma_f32_16x16x32_bf16 v[168:171], v[24:27], v[56:59], v[168:171]
    ds_read_b64_tr_b16 v[42:43], v14 offset:33792
    v_mfma_f32_16x16x32_bf16 v[172:175], v[24:27], v[60:63], v[172:175]
    ds_read_b128 v[24:27], v9 offset:32768
    v_mfma_f32_16x16x32_bf16 v[176:179], v[28:31], v[48:51], v[176:179]
    ds_read_b64_tr_b16 v[44:45], v15 offset:32768
    v_mfma_f32_16x16x32_bf16 v[180:183], v[28:31], v[52:55], v[180:183]
    ds_read_b64_tr_b16 v[46:47], v15 offset:33792
    v_mfma_f32_16x16x32_bf16 v[184:187], v[28:31], v[56:59], v[184:187]
    v_mfma_f32_16x16x32_bf16 v[188:191], v[28:31], v[60:63], v[188:191]
    ds_read_b128 v[28:31], v9 offset:34816
    s_waitcnt lgkmcnt(9)
    v_mfma_f32_16x16x32_bf16 v[128:131], v[16:19], v[32:35], v[128:131]
    ds_read_b64_tr_b16 v[48:49], v12 offset:40960
    s_waitcnt lgkmcnt(7)
    v_mfma_f32_16x16x32_bf16 v[132:135], v[16:19], v[36:39], v[132:135]
    ds_read_b64_tr_b16 v[50:51], v12 offset:41984
    s_waitcnt lgkmcnt(6)
    v_mfma_f32_16x16x32_bf16 v[136:139], v[16:19], v[40:43], v[136:139]
    ds_read_b64_tr_b16 v[52:53], v13 offset:40960
    s_waitcnt lgkmcnt(4)
    v_mfma_f32_16x16x32_bf16 v[140:143], v[16:19], v[44:47], v[140:143]
    ds_read_b128 v[16:19], v10 offset:32768
    v_mfma_f32_16x16x32_bf16 v[144:147], v[20:23], v[32:35], v[144:147]
    ds_read_b64_tr_b16 v[54:55], v13 offset:41984
    v_mfma_f32_16x16x32_bf16 v[148:151], v[20:23], v[36:39], v[148:151]
    ds_read_b64_tr_b16 v[56:57], v14 offset:40960
    v_mfma_f32_16x16x32_bf16 v[152:155], v[20:23], v[40:43], v[152:155]
    ds_read_b64_tr_b16 v[58:59], v14 offset:41984
    v_mfma_f32_16x16x32_bf16 v[156:159], v[20:23], v[44:47], v[156:159]
    ds_read_b128 v[20:23], v10 offset:34816
    v_mfma_f32_16x16x32_bf16 v[160:163], v[24:27], v[32:35], v[160:163]
    ds_read_b64_tr_b16 v[60:61], v15 offset:40960
    v_mfma_f32_16x16x32_bf16 v[164:167], v[24:27], v[36:39], v[164:167]
    ds_read_b64_tr_b16 v[62:63], v15 offset:41984
    v_mfma_f32_16x16x32_bf16 v[168:171], v[24:27], v[40:43], v[168:171]
    v_add_u32 v8, 0xffff0000, v8
    v_add_u32 v9, 0xffff0000, v9
    v_mfma_f32_16x16x32_bf16 v[172:175], v[24:27], v[44:47], v[172:175]
    ds_read_b128 v[24:27], v11 offset:32768
    s_waitcnt lgkmcnt(11)
    v_mfma_f32_16x16x32_bf16 v[176:179], v[28:31], v[32:35], v[176:179]
    v_add_u32 v12, 0xffff0000, v12
    v_mfma_f32_16x16x32_bf16 v[180:183], v[28:31], v[36:39], v[180:183]
    v_add_u32 v13, 0xffff0000, v13
    v_mfma_f32_16x16x32_bf16 v[184:187], v[28:31], v[40:43], v[184:187]
    v_add_u32 v14, 0xffff0000, v14
    v_add_u32 v15, 0xffff0000, v15
    v_mfma_f32_16x16x32_bf16 v[188:191], v[28:31], v[44:47], v[188:191]
    ds_read_b128 v[28:31], v11 offset:34816
    s_waitcnt lgkmcnt(8)
    v_mfma_f32_16x16x32_bf16 v[128:131], v[16:19], v[48:51], v[128:131]
    v_add_u32 v10, 0xffff0000, v10
    s_waitcnt lgkmcnt(7)
    v_mfma_f32_16x16x32_bf16 v[132:135], v[16:19], v[52:55], v[132:135]
    v_add_u32 v11, 0xffff0000, v11
    s_waitcnt lgkmcnt(5)
    v_mfma_f32_16x16x32_bf16 v[136:139], v[16:19], v[56:59], v[136:139]
    s_waitcnt lgkmcnt(2)
    v_mfma_f32_16x16x32_bf16 v[140:143], v[16:19], v[60:63], v[140:143]
    s_waitcnt lgkmcnt(0)
    s_barrier
    ds_read_b128 v[16:19], v8 offset:0
    v_mfma_f32_16x16x32_bf16 v[144:147], v[20:23], v[48:51], v[144:147]
    ds_read_b64_tr_b16 v[32:33], v12 offset:0
    ds_read_b128 v[96:99], v119 offset:0
    ds_read_b128 v[100:103], v120 offset:0
    v_mfma_f32_16x16x32_bf16 v[148:151], v[20:23], v[52:55], v[148:151]
    ds_read_b64_tr_b16 v[34:35], v12 offset:1024
    ds_read_b128 v[104:107], v121 offset:0
    ds_read_b128 v[108:111], v122 offset:0
    v_mfma_f32_16x16x32_bf16 v[152:155], v[20:23], v[56:59], v[152:155]
    ds_read_b64_tr_b16 v[36:37], v13 offset:0
    v_mfma_f32_16x16x32_bf16 v[156:159], v[20:23], v[60:63], v[156:159]
    ds_read_b128 v[20:23], v8 offset:2048
    v_mfma_f32_16x16x32_bf16 v[160:163], v[24:27], v[48:51], v[160:163]
    ds_read_b64_tr_b16 v[38:39], v13 offset:1024
    v_mfma_f32_16x16x32_bf16 v[164:167], v[24:27], v[52:55], v[164:167]
    ds_read_b64_tr_b16 v[40:41], v14 offset:0
    v_mfma_f32_16x16x32_bf16 v[168:171], v[24:27], v[56:59], v[168:171]
    ds_read_b64_tr_b16 v[42:43], v14 offset:1024
    v_mfma_f32_16x16x32_bf16 v[172:175], v[24:27], v[60:63], v[172:175]
    ds_read_b128 v[24:27], v9 offset:0
    v_mfma_f32_16x16x32_bf16 v[176:179], v[28:31], v[48:51], v[176:179]
    ds_read_b64_tr_b16 v[44:45], v15 offset:0
    v_mfma_f32_16x16x32_bf16 v[180:183], v[28:31], v[52:55], v[180:183]
    ds_read_b64_tr_b16 v[46:47], v15 offset:1024
    v_mfma_f32_16x16x32_bf16 v[184:187], v[28:31], v[56:59], v[184:187]
    v_mfma_f32_16x16x32_bf16 v[188:191], v[28:31], v[60:63], v[188:191]
    ds_read_b128 v[28:31], v9 offset:2048
    s_waitcnt lgkmcnt(13)
    v_mfma_f32_16x16x32_bf16 v[192:195], v[64:67], v[96:99], 0
    s_waitcnt lgkmcnt(12)
    v_mfma_f32_16x16x32_bf16 v[208:211], v[64:67], v[100:103], 0
    v_cvt_pk_bf16_f32 v64, v128, v129
    v_cvt_pk_bf16_f32 v65, v130, v131
    v_mfma_f32_16x16x32_bf16 v[196:199], v[68:71], v[96:99], 0
    v_cvt_pk_bf16_f32 v66, v144, v145
    v_cvt_pk_bf16_f32 v67, v146, v147
    v_mfma_f32_16x16x32_bf16 v[212:215], v[68:71], v[100:103], 0
    v_cvt_pk_bf16_f32 v68, v132, v133
    v_cvt_pk_bf16_f32 v69, v134, v135
    v_mfma_f32_16x16x32_bf16 v[200:203], v[72:75], v[96:99], 0
    v_cvt_pk_bf16_f32 v70, v148, v149
    v_cvt_pk_bf16_f32 v71, v150, v151
    v_mfma_f32_16x16x32_bf16 v[216:219], v[72:75], v[100:103], 0
    v_cvt_pk_bf16_f32 v72, v136, v137
    v_cvt_pk_bf16_f32 v73, v138, v139
    v_mfma_f32_16x16x32_bf16 v[204:207], v[76:79], v[96:99], 0
    v_cvt_pk_bf16_f32 v74, v152, v153
    v_cvt_pk_bf16_f32 v75, v154, v155
    v_mfma_f32_16x16x32_bf16 v[220:223], v[76:79], v[100:103], 0
    v_cvt_pk_bf16_f32 v76, v140, v141
    v_cvt_pk_bf16_f32 v77, v142, v143
    s_waitcnt lgkmcnt(10)
    v_mfma_f32_16x16x32_bf16 v[224:227], v[80:83], v[104:107], 0
    v_cvt_pk_bf16_f32 v78, v156, v157
    v_cvt_pk_bf16_f32 v79, v158, v159
    s_waitcnt lgkmcnt(9)
    v_mfma_f32_16x16x32_bf16 v[240:243], v[80:83], v[108:111], 0
    v_cvt_pk_bf16_f32 v80, v160, v161
    v_cvt_pk_bf16_f32 v81, v162, v163
    v_mfma_f32_16x16x32_bf16 v[228:231], v[84:87], v[104:107], 0
    v_cvt_pk_bf16_f32 v82, v176, v177
    v_cvt_pk_bf16_f32 v83, v178, v179
    v_mfma_f32_16x16x32_bf16 v[244:247], v[84:87], v[108:111], 0
    v_cvt_pk_bf16_f32 v84, v164, v165
    v_cvt_pk_bf16_f32 v85, v166, v167
    v_mfma_f32_16x16x32_bf16 v[232:235], v[88:91], v[104:107], 0
    v_cvt_pk_bf16_f32 v86, v180, v181
    v_cvt_pk_bf16_f32 v87, v182, v183
    v_mfma_f32_16x16x32_bf16 v[248:251], v[88:91], v[108:111], 0
    v_cvt_pk_bf16_f32 v88, v168, v169
    v_cvt_pk_bf16_f32 v89, v170, v171
    v_mfma_f32_16x16x32_bf16 v[236:239], v[92:95], v[104:107], 0
    v_cvt_pk_bf16_f32 v90, v184, v185
    v_cvt_pk_bf16_f32 v91, v186, v187
    v_mfma_f32_16x16x32_bf16 v[252:255], v[92:95], v[108:111], 0
    v_cvt_pk_bf16_f32 v92, v172, v173
    v_cvt_pk_bf16_f32 v93, v174, v175
    v_cvt_pk_bf16_f32 v94, v188, v189
    v_cvt_pk_bf16_f32 v95, v190, v191
    v_mfma_f32_16x16x32_bf16 v[128:131], v[16:19], v[32:35], 0
    ds_read_b64_tr_b16 v[48:49], v12 offset:8192
    s_waitcnt lgkmcnt(7)
    v_mfma_f32_16x16x32_bf16 v[132:135], v[16:19], v[36:39], 0
    ds_read_b64_tr_b16 v[50:51], v12 offset:9216
    s_waitcnt lgkmcnt(6)
    v_mfma_f32_16x16x32_bf16 v[136:139], v[16:19], v[40:43], 0
    ds_read_b64_tr_b16 v[52:53], v13 offset:8192
    s_waitcnt lgkmcnt(4)
    v_mfma_f32_16x16x32_bf16 v[140:143], v[16:19], v[44:47], 0
    ds_read_b128 v[16:19], v10 offset:0
    v_mfma_f32_16x16x32_bf16 v[144:147], v[20:23], v[32:35], 0
    ds_read_b64_tr_b16 v[54:55], v13 offset:9216
    v_mfma_f32_16x16x32_bf16 v[148:151], v[20:23], v[36:39], 0
    ds_read_b64_tr_b16 v[56:57], v14 offset:8192
    v_mfma_f32_16x16x32_bf16 v[152:155], v[20:23], v[40:43], 0
    ds_read_b64_tr_b16 v[58:59], v14 offset:9216
    v_mfma_f32_16x16x32_bf16 v[156:159], v[20:23], v[44:47], 0
    ds_read_b128 v[20:23], v10 offset:2048
    v_mfma_f32_16x16x32_bf16 v[160:163], v[24:27], v[32:35], 0
    ds_read_b64_tr_b16 v[60:61], v15 offset:8192
    v_mfma_f32_16x16x32_bf16 v[164:167], v[24:27], v[36:39], 0
    ds_read_b64_tr_b16 v[62:63], v15 offset:9216
    v_mfma_f32_16x16x32_bf16 v[168:171], v[24:27], v[40:43], 0
    v_mfma_f32_16x16x32_bf16 v[172:175], v[24:27], v[44:47], 0
    ds_read_b128 v[24:27], v11 offset:0
    s_waitcnt lgkmcnt(11)
    v_mfma_f32_16x16x32_bf16 v[176:179], v[28:31], v[32:35], 0
    v_mfma_f32_16x16x32_bf16 v[180:183], v[28:31], v[36:39], 0
    v_mfma_f32_16x16x32_bf16 v[184:187], v[28:31], v[40:43], 0
    v_mfma_f32_16x16x32_bf16 v[188:191], v[28:31], v[44:47], 0
    ds_read_b128 v[28:31], v11 offset:2048
    s_waitcnt lgkmcnt(8)
    v_mfma_f32_16x16x32_bf16 v[128:131], v[16:19], v[48:51], v[128:131]
    s_waitcnt lgkmcnt(7)
    v_mfma_f32_16x16x32_bf16 v[132:135], v[16:19], v[52:55], v[132:135]
    s_waitcnt lgkmcnt(5)
    v_mfma_f32_16x16x32_bf16 v[136:139], v[16:19], v[56:59], v[136:139]
    s_waitcnt lgkmcnt(2)
    v_mfma_f32_16x16x32_bf16 v[140:143], v[16:19], v[60:63], v[140:143]
    s_waitcnt lgkmcnt(0)
    s_barrier
    ds_read_b128 v[16:19], v8 offset:32768
    v_mfma_f32_16x16x32_bf16 v[144:147], v[20:23], v[48:51], v[144:147]
    ds_read_b64_tr_b16 v[32:33], v12 offset:32768
    v_mfma_f32_16x16x32_bf16 v[148:151], v[20:23], v[52:55], v[148:151]
    ds_read_b64_tr_b16 v[34:35], v12 offset:33792
    v_mfma_f32_16x16x32_bf16 v[152:155], v[20:23], v[56:59], v[152:155]
    ds_read_b64_tr_b16 v[36:37], v13 offset:32768
    v_mfma_f32_16x16x32_bf16 v[156:159], v[20:23], v[60:63], v[156:159]
    ds_read_b128 v[20:23], v8 offset:34816
    v_mfma_f32_16x16x32_bf16 v[160:163], v[24:27], v[48:51], v[160:163]
    ds_read_b64_tr_b16 v[38:39], v13 offset:33792
    v_mfma_f32_16x16x32_bf16 v[164:167], v[24:27], v[52:55], v[164:167]
    ds_read_b64_tr_b16 v[40:41], v14 offset:32768
    v_mfma_f32_16x16x32_bf16 v[168:171], v[24:27], v[56:59], v[168:171]
    ds_read_b64_tr_b16 v[42:43], v14 offset:33792
    v_mfma_f32_16x16x32_bf16 v[172:175], v[24:27], v[60:63], v[172:175]
    ds_read_b128 v[24:27], v9 offset:32768
    v_mfma_f32_16x16x32_bf16 v[176:179], v[28:31], v[48:51], v[176:179]
    ds_read_b64_tr_b16 v[44:45], v15 offset:32768
    v_mfma_f32_16x16x32_bf16 v[180:183], v[28:31], v[52:55], v[180:183]
    ds_read_b64_tr_b16 v[46:47], v15 offset:33792
    v_mfma_f32_16x16x32_bf16 v[184:187], v[28:31], v[56:59], v[184:187]
    v_mfma_f32_16x16x32_bf16 v[188:191], v[28:31], v[60:63], v[188:191]
    ds_read_b128 v[28:31], v9 offset:34816
    s_waitcnt lgkmcnt(9)
    v_mfma_f32_16x16x32_bf16 v[128:131], v[16:19], v[32:35], v[128:131]
    ds_read_b64_tr_b16 v[48:49], v12 offset:40960
    s_waitcnt lgkmcnt(7)
    v_mfma_f32_16x16x32_bf16 v[132:135], v[16:19], v[36:39], v[132:135]
    ds_read_b64_tr_b16 v[50:51], v12 offset:41984
    s_waitcnt lgkmcnt(6)
    v_mfma_f32_16x16x32_bf16 v[136:139], v[16:19], v[40:43], v[136:139]
    ds_read_b64_tr_b16 v[52:53], v13 offset:40960
    s_waitcnt lgkmcnt(4)
    v_mfma_f32_16x16x32_bf16 v[140:143], v[16:19], v[44:47], v[140:143]
    ds_read_b128 v[16:19], v10 offset:32768
    v_mfma_f32_16x16x32_bf16 v[144:147], v[20:23], v[32:35], v[144:147]
    ds_read_b64_tr_b16 v[54:55], v13 offset:41984
    v_mfma_f32_16x16x32_bf16 v[148:151], v[20:23], v[36:39], v[148:151]
    ds_read_b64_tr_b16 v[56:57], v14 offset:40960
    v_mfma_f32_16x16x32_bf16 v[152:155], v[20:23], v[40:43], v[152:155]
    ds_read_b64_tr_b16 v[58:59], v14 offset:41984
    v_mfma_f32_16x16x32_bf16 v[156:159], v[20:23], v[44:47], v[156:159]
    ds_read_b128 v[20:23], v10 offset:34816
    v_mfma_f32_16x16x32_bf16 v[160:163], v[24:27], v[32:35], v[160:163]
    ds_read_b64_tr_b16 v[60:61], v15 offset:40960
    v_mfma_f32_16x16x32_bf16 v[164:167], v[24:27], v[36:39], v[164:167]
    ds_read_b64_tr_b16 v[62:63], v15 offset:41984
    v_mfma_f32_16x16x32_bf16 v[168:171], v[24:27], v[40:43], v[168:171]
    v_add_u32 v8, 0x10000, v8
    v_add_u32 v9, 0x10000, v9
    v_mfma_f32_16x16x32_bf16 v[172:175], v[24:27], v[44:47], v[172:175]
    ds_read_b128 v[24:27], v11 offset:32768
    s_waitcnt lgkmcnt(11)
    v_mfma_f32_16x16x32_bf16 v[176:179], v[28:31], v[32:35], v[176:179]
    v_add_u32 v12, 0x10000, v12
    v_mfma_f32_16x16x32_bf16 v[180:183], v[28:31], v[36:39], v[180:183]
    v_add_u32 v13, 0x10000, v13
    v_mfma_f32_16x16x32_bf16 v[184:187], v[28:31], v[40:43], v[184:187]
    v_add_u32 v14, 0x10000, v14
    v_add_u32 v15, 0x10000, v15
    v_mfma_f32_16x16x32_bf16 v[188:191], v[28:31], v[44:47], v[188:191]
    ds_read_b128 v[28:31], v11 offset:34816
    s_waitcnt lgkmcnt(8)
    v_mfma_f32_16x16x32_bf16 v[128:131], v[16:19], v[48:51], v[128:131]
    v_add_u32 v10, 0x10000, v10
    s_waitcnt lgkmcnt(7)
    v_mfma_f32_16x16x32_bf16 v[132:135], v[16:19], v[52:55], v[132:135]
    v_add_u32 v11, 0x10000, v11
    s_waitcnt lgkmcnt(5)
    v_mfma_f32_16x16x32_bf16 v[136:139], v[16:19], v[56:59], v[136:139]
    s_waitcnt lgkmcnt(2)
    v_mfma_f32_16x16x32_bf16 v[140:143], v[16:19], v[60:63], v[140:143]
    s_waitcnt lgkmcnt(0)
    s_barrier
    ds_read_b128 v[16:19], v8 offset:0
    v_mfma_f32_16x16x32_bf16 v[144:147], v[20:23], v[48:51], v[144:147]
    ds_read_b64_tr_b16 v[32:33], v12 offset:0
    ds_read_b128 v[96:99], v119 offset:8192
    ds_read_b128 v[100:103], v120 offset:8192
    v_mfma_f32_16x16x32_bf16 v[148:151], v[20:23], v[52:55], v[148:151]
    ds_read_b64_tr_b16 v[34:35], v12 offset:1024
    ds_read_b128 v[104:107], v121 offset:8192
    ds_read_b128 v[108:111], v122 offset:8192
    v_mfma_f32_16x16x32_bf16 v[152:155], v[20:23], v[56:59], v[152:155]
    ds_read_b64_tr_b16 v[36:37], v13 offset:0
    v_mfma_f32_16x16x32_bf16 v[156:159], v[20:23], v[60:63], v[156:159]
    ds_read_b128 v[20:23], v8 offset:2048
    v_mfma_f32_16x16x32_bf16 v[160:163], v[24:27], v[48:51], v[160:163]
    ds_read_b64_tr_b16 v[38:39], v13 offset:1024
    v_mfma_f32_16x16x32_bf16 v[164:167], v[24:27], v[52:55], v[164:167]
    ds_read_b64_tr_b16 v[40:41], v14 offset:0
    v_mfma_f32_16x16x32_bf16 v[168:171], v[24:27], v[56:59], v[168:171]
    ds_read_b64_tr_b16 v[42:43], v14 offset:1024
    v_mfma_f32_16x16x32_bf16 v[172:175], v[24:27], v[60:63], v[172:175]
    ds_read_b128 v[24:27], v9 offset:0
    v_mfma_f32_16x16x32_bf16 v[176:179], v[28:31], v[48:51], v[176:179]
    ds_read_b64_tr_b16 v[44:45], v15 offset:0
    v_mfma_f32_16x16x32_bf16 v[180:183], v[28:31], v[52:55], v[180:183]
    ds_read_b64_tr_b16 v[46:47], v15 offset:1024
    v_mfma_f32_16x16x32_bf16 v[184:187], v[28:31], v[56:59], v[184:187]
    v_mfma_f32_16x16x32_bf16 v[188:191], v[28:31], v[60:63], v[188:191]
    ds_read_b128 v[28:31], v9 offset:2048
    s_waitcnt lgkmcnt(13)
    v_mfma_f32_16x16x32_bf16 v[192:195], v[64:67], v[96:99], v[192:195]
    s_waitcnt lgkmcnt(12)
    v_mfma_f32_16x16x32_bf16 v[208:211], v[64:67], v[100:103], v[208:211]
    v_cvt_pk_bf16_f32 v64, v128, v129
    v_cvt_pk_bf16_f32 v65, v130, v131
    v_mfma_f32_16x16x32_bf16 v[196:199], v[68:71], v[96:99], v[196:199]
    v_cvt_pk_bf16_f32 v66, v144, v145
    v_cvt_pk_bf16_f32 v67, v146, v147
    v_mfma_f32_16x16x32_bf16 v[212:215], v[68:71], v[100:103], v[212:215]
    v_cvt_pk_bf16_f32 v68, v132, v133
    v_cvt_pk_bf16_f32 v69, v134, v135
    v_mfma_f32_16x16x32_bf16 v[200:203], v[72:75], v[96:99], v[200:203]
    v_cvt_pk_bf16_f32 v70, v148, v149
    v_cvt_pk_bf16_f32 v71, v150, v151
    v_mfma_f32_16x16x32_bf16 v[216:219], v[72:75], v[100:103], v[216:219]
    v_cvt_pk_bf16_f32 v72, v136, v137
    v_cvt_pk_bf16_f32 v73, v138, v139
    v_mfma_f32_16x16x32_bf16 v[204:207], v[76:79], v[96:99], v[204:207]
    v_cvt_pk_bf16_f32 v74, v152, v153
    v_cvt_pk_bf16_f32 v75, v154, v155
    v_mfma_f32_16x16x32_bf16 v[220:223], v[76:79], v[100:103], v[220:223]
    v_cvt_pk_bf16_f32 v76, v140, v141
    v_cvt_pk_bf16_f32 v77, v142, v143
    s_waitcnt lgkmcnt(10)
    v_mfma_f32_16x16x32_bf16 v[224:227], v[80:83], v[104:107], v[224:227]
    v_cvt_pk_bf16_f32 v78, v156, v157
    v_cvt_pk_bf16_f32 v79, v158, v159
    s_waitcnt lgkmcnt(9)
    v_mfma_f32_16x16x32_bf16 v[240:243], v[80:83], v[108:111], v[240:243]
    v_cvt_pk_bf16_f32 v80, v160, v161
    v_cvt_pk_bf16_f32 v81, v162, v163
    v_mfma_f32_16x16x32_bf16 v[228:231], v[84:87], v[104:107], v[228:231]
    v_cvt_pk_bf16_f32 v82, v176, v177
    v_cvt_pk_bf16_f32 v83, v178, v179
    v_mfma_f32_16x16x32_bf16 v[244:247], v[84:87], v[108:111], v[244:247]
    v_cvt_pk_bf16_f32 v84, v164, v165
    v_cvt_pk_bf16_f32 v85, v166, v167
    v_mfma_f32_16x16x32_bf16 v[232:235], v[88:91], v[104:107], v[232:235]
    v_cvt_pk_bf16_f32 v86, v180, v181
    v_cvt_pk_bf16_f32 v87, v182, v183
    v_mfma_f32_16x16x32_bf16 v[248:251], v[88:91], v[108:111], v[248:251]
    v_cvt_pk_bf16_f32 v88, v168, v169
    v_cvt_pk_bf16_f32 v89, v170, v171
    v_mfma_f32_16x16x32_bf16 v[236:239], v[92:95], v[104:107], v[236:239]
    v_cvt_pk_bf16_f32 v90, v184, v185
    v_cvt_pk_bf16_f32 v91, v186, v187
    v_mfma_f32_16x16x32_bf16 v[252:255], v[92:95], v[108:111], v[252:255]
    v_cvt_pk_bf16_f32 v92, v172, v173
    v_cvt_pk_bf16_f32 v93, v174, v175
    v_cvt_pk_bf16_f32 v94, v188, v189
    v_cvt_pk_bf16_f32 v95, v190, v191
    v_mfma_f32_16x16x32_bf16 v[128:131], v[16:19], v[32:35], 0
    ds_read_b64_tr_b16 v[48:49], v12 offset:8192
    s_waitcnt lgkmcnt(7)
    v_mfma_f32_16x16x32_bf16 v[132:135], v[16:19], v[36:39], 0
    ds_read_b64_tr_b16 v[50:51], v12 offset:9216
    s_waitcnt lgkmcnt(6)
    v_mfma_f32_16x16x32_bf16 v[136:139], v[16:19], v[40:43], 0
    ds_read_b64_tr_b16 v[52:53], v13 offset:8192
    s_waitcnt lgkmcnt(4)
    v_mfma_f32_16x16x32_bf16 v[140:143], v[16:19], v[44:47], 0
    ds_read_b128 v[16:19], v10 offset:0
    v_mfma_f32_16x16x32_bf16 v[144:147], v[20:23], v[32:35], 0
    ds_read_b64_tr_b16 v[54:55], v13 offset:9216
    v_mfma_f32_16x16x32_bf16 v[148:151], v[20:23], v[36:39], 0
    ds_read_b64_tr_b16 v[56:57], v14 offset:8192
    v_mfma_f32_16x16x32_bf16 v[152:155], v[20:23], v[40:43], 0
    ds_read_b64_tr_b16 v[58:59], v14 offset:9216
    v_mfma_f32_16x16x32_bf16 v[156:159], v[20:23], v[44:47], 0
    ds_read_b128 v[20:23], v10 offset:2048
    v_mfma_f32_16x16x32_bf16 v[160:163], v[24:27], v[32:35], 0
    ds_read_b64_tr_b16 v[60:61], v15 offset:8192
    v_mfma_f32_16x16x32_bf16 v[164:167], v[24:27], v[36:39], 0
    ds_read_b64_tr_b16 v[62:63], v15 offset:9216
    v_mfma_f32_16x16x32_bf16 v[168:171], v[24:27], v[40:43], 0
    v_mfma_f32_16x16x32_bf16 v[172:175], v[24:27], v[44:47], 0
    ds_read_b128 v[24:27], v11 offset:0
    s_waitcnt lgkmcnt(11)
    v_mfma_f32_16x16x32_bf16 v[176:179], v[28:31], v[32:35], 0
    v_mfma_f32_16x16x32_bf16 v[180:183], v[28:31], v[36:39], 0
    v_mfma_f32_16x16x32_bf16 v[184:187], v[28:31], v[40:43], 0
    v_mfma_f32_16x16x32_bf16 v[188:191], v[28:31], v[44:47], 0
    ds_read_b128 v[28:31], v11 offset:2048
    s_waitcnt lgkmcnt(8)
    v_mfma_f32_16x16x32_bf16 v[128:131], v[16:19], v[48:51], v[128:131]
    s_waitcnt lgkmcnt(7)
    v_mfma_f32_16x16x32_bf16 v[132:135], v[16:19], v[52:55], v[132:135]
    s_waitcnt lgkmcnt(5)
    v_mfma_f32_16x16x32_bf16 v[136:139], v[16:19], v[56:59], v[136:139]
    s_waitcnt lgkmcnt(2)
    v_mfma_f32_16x16x32_bf16 v[140:143], v[16:19], v[60:63], v[140:143]
    s_waitcnt lgkmcnt(0)
    s_barrier
    ds_read_b128 v[16:19], v8 offset:32768
    v_mfma_f32_16x16x32_bf16 v[144:147], v[20:23], v[48:51], v[144:147]
    ds_read_b64_tr_b16 v[32:33], v12 offset:32768
    v_mfma_f32_16x16x32_bf16 v[148:151], v[20:23], v[52:55], v[148:151]
    ds_read_b64_tr_b16 v[34:35], v12 offset:33792
    v_mfma_f32_16x16x32_bf16 v[152:155], v[20:23], v[56:59], v[152:155]
    ds_read_b64_tr_b16 v[36:37], v13 offset:32768
    v_mfma_f32_16x16x32_bf16 v[156:159], v[20:23], v[60:63], v[156:159]
    ds_read_b128 v[20:23], v8 offset:34816
    v_mfma_f32_16x16x32_bf16 v[160:163], v[24:27], v[48:51], v[160:163]
    ds_read_b64_tr_b16 v[38:39], v13 offset:33792
    v_mfma_f32_16x16x32_bf16 v[164:167], v[24:27], v[52:55], v[164:167]
    ds_read_b64_tr_b16 v[40:41], v14 offset:32768
    v_mfma_f32_16x16x32_bf16 v[168:171], v[24:27], v[56:59], v[168:171]
    ds_read_b64_tr_b16 v[42:43], v14 offset:33792
    v_mfma_f32_16x16x32_bf16 v[172:175], v[24:27], v[60:63], v[172:175]
    ds_read_b128 v[24:27], v9 offset:32768
    v_mfma_f32_16x16x32_bf16 v[176:179], v[28:31], v[48:51], v[176:179]
    ds_read_b64_tr_b16 v[44:45], v15 offset:32768
    v_mfma_f32_16x16x32_bf16 v[180:183], v[28:31], v[52:55], v[180:183]
    ds_read_b64_tr_b16 v[46:47], v15 offset:33792
    v_mfma_f32_16x16x32_bf16 v[184:187], v[28:31], v[56:59], v[184:187]
    v_mfma_f32_16x16x32_bf16 v[188:191], v[28:31], v[60:63], v[188:191]
    ds_read_b128 v[28:31], v9 offset:34816
    s_waitcnt lgkmcnt(9)
    v_mfma_f32_16x16x32_bf16 v[128:131], v[16:19], v[32:35], v[128:131]
    ds_read_b64_tr_b16 v[48:49], v12 offset:40960
    s_waitcnt lgkmcnt(7)
    v_mfma_f32_16x16x32_bf16 v[132:135], v[16:19], v[36:39], v[132:135]
    ds_read_b64_tr_b16 v[50:51], v12 offset:41984
    s_waitcnt lgkmcnt(6)
    v_mfma_f32_16x16x32_bf16 v[136:139], v[16:19], v[40:43], v[136:139]
    ds_read_b64_tr_b16 v[52:53], v13 offset:40960
    s_waitcnt lgkmcnt(4)
    v_mfma_f32_16x16x32_bf16 v[140:143], v[16:19], v[44:47], v[140:143]
    ds_read_b128 v[16:19], v10 offset:32768
    v_mfma_f32_16x16x32_bf16 v[144:147], v[20:23], v[32:35], v[144:147]
    ds_read_b64_tr_b16 v[54:55], v13 offset:41984
    v_mfma_f32_16x16x32_bf16 v[148:151], v[20:23], v[36:39], v[148:151]
    ds_read_b64_tr_b16 v[56:57], v14 offset:40960
    v_mfma_f32_16x16x32_bf16 v[152:155], v[20:23], v[40:43], v[152:155]
    ds_read_b64_tr_b16 v[58:59], v14 offset:41984
    v_mfma_f32_16x16x32_bf16 v[156:159], v[20:23], v[44:47], v[156:159]
    ds_read_b128 v[20:23], v10 offset:34816
    v_mfma_f32_16x16x32_bf16 v[160:163], v[24:27], v[32:35], v[160:163]
    ds_read_b64_tr_b16 v[60:61], v15 offset:40960
    v_mfma_f32_16x16x32_bf16 v[164:167], v[24:27], v[36:39], v[164:167]
    ds_read_b64_tr_b16 v[62:63], v15 offset:41984
    v_mfma_f32_16x16x32_bf16 v[168:171], v[24:27], v[40:43], v[168:171]
    v_add_u32 v8, 0xffff0000, v8
    v_add_u32 v9, 0xffff0000, v9
    v_mfma_f32_16x16x32_bf16 v[172:175], v[24:27], v[44:47], v[172:175]
    ds_read_b128 v[24:27], v11 offset:32768
    s_waitcnt lgkmcnt(11)
    v_mfma_f32_16x16x32_bf16 v[176:179], v[28:31], v[32:35], v[176:179]
    v_add_u32 v12, 0xffff0000, v12
    v_mfma_f32_16x16x32_bf16 v[180:183], v[28:31], v[36:39], v[180:183]
    v_add_u32 v13, 0xffff0000, v13
    v_mfma_f32_16x16x32_bf16 v[184:187], v[28:31], v[40:43], v[184:187]
    v_add_u32 v14, 0xffff0000, v14
    v_add_u32 v15, 0xffff0000, v15
    v_mfma_f32_16x16x32_bf16 v[188:191], v[28:31], v[44:47], v[188:191]
    ds_read_b128 v[28:31], v11 offset:34816
    s_waitcnt lgkmcnt(8)
    v_mfma_f32_16x16x32_bf16 v[128:131], v[16:19], v[48:51], v[128:131]
    v_add_u32 v10, 0xffff0000, v10
    s_waitcnt lgkmcnt(7)
    v_mfma_f32_16x16x32_bf16 v[132:135], v[16:19], v[52:55], v[132:135]
    v_add_u32 v11, 0xffff0000, v11
    s_waitcnt lgkmcnt(5)
    v_mfma_f32_16x16x32_bf16 v[136:139], v[16:19], v[56:59], v[136:139]
    s_waitcnt lgkmcnt(2)
    v_mfma_f32_16x16x32_bf16 v[140:143], v[16:19], v[60:63], v[140:143]
    s_waitcnt lgkmcnt(0)
    s_barrier
    ds_read_b128 v[16:19], v8 offset:0
    v_mfma_f32_16x16x32_bf16 v[144:147], v[20:23], v[48:51], v[144:147]
    ds_read_b64_tr_b16 v[32:33], v12 offset:0
    ds_read_b128 v[96:99], v119 offset:16384
    ds_read_b128 v[100:103], v120 offset:16384
    v_mfma_f32_16x16x32_bf16 v[148:151], v[20:23], v[52:55], v[148:151]
    ds_read_b64_tr_b16 v[34:35], v12 offset:1024
    ds_read_b128 v[104:107], v121 offset:16384
    ds_read_b128 v[108:111], v122 offset:16384
    v_mfma_f32_16x16x32_bf16 v[152:155], v[20:23], v[56:59], v[152:155]
    ds_read_b64_tr_b16 v[36:37], v13 offset:0
    v_mfma_f32_16x16x32_bf16 v[156:159], v[20:23], v[60:63], v[156:159]
    ds_read_b128 v[20:23], v8 offset:2048
    v_mfma_f32_16x16x32_bf16 v[160:163], v[24:27], v[48:51], v[160:163]
    ds_read_b64_tr_b16 v[38:39], v13 offset:1024
    v_mfma_f32_16x16x32_bf16 v[164:167], v[24:27], v[52:55], v[164:167]
    ds_read_b64_tr_b16 v[40:41], v14 offset:0
    v_mfma_f32_16x16x32_bf16 v[168:171], v[24:27], v[56:59], v[168:171]
    ds_read_b64_tr_b16 v[42:43], v14 offset:1024
    v_mfma_f32_16x16x32_bf16 v[172:175], v[24:27], v[60:63], v[172:175]
    ds_read_b128 v[24:27], v9 offset:0
    v_mfma_f32_16x16x32_bf16 v[176:179], v[28:31], v[48:51], v[176:179]
    ds_read_b64_tr_b16 v[44:45], v15 offset:0
    v_mfma_f32_16x16x32_bf16 v[180:183], v[28:31], v[52:55], v[180:183]
    ds_read_b64_tr_b16 v[46:47], v15 offset:1024
    v_mfma_f32_16x16x32_bf16 v[184:187], v[28:31], v[56:59], v[184:187]
    v_mfma_f32_16x16x32_bf16 v[188:191], v[28:31], v[60:63], v[188:191]
    ds_read_b128 v[28:31], v9 offset:2048
    s_waitcnt lgkmcnt(13)
    v_mfma_f32_16x16x32_bf16 v[192:195], v[64:67], v[96:99], v[192:195]
    s_waitcnt lgkmcnt(12)
    v_mfma_f32_16x16x32_bf16 v[208:211], v[64:67], v[100:103], v[208:211]
    v_cvt_pk_bf16_f32 v64, v128, v129
    v_cvt_pk_bf16_f32 v65, v130, v131
    v_mfma_f32_16x16x32_bf16 v[196:199], v[68:71], v[96:99], v[196:199]
    v_cvt_pk_bf16_f32 v66, v144, v145
    v_cvt_pk_bf16_f32 v67, v146, v147
    v_mfma_f32_16x16x32_bf16 v[212:215], v[68:71], v[100:103], v[212:215]
    v_cvt_pk_bf16_f32 v68, v132, v133
    v_cvt_pk_bf16_f32 v69, v134, v135
    v_mfma_f32_16x16x32_bf16 v[200:203], v[72:75], v[96:99], v[200:203]
    v_cvt_pk_bf16_f32 v70, v148, v149
    v_cvt_pk_bf16_f32 v71, v150, v151
    v_mfma_f32_16x16x32_bf16 v[216:219], v[72:75], v[100:103], v[216:219]
    v_cvt_pk_bf16_f32 v72, v136, v137
    v_cvt_pk_bf16_f32 v73, v138, v139
    v_mfma_f32_16x16x32_bf16 v[204:207], v[76:79], v[96:99], v[204:207]
    v_cvt_pk_bf16_f32 v74, v152, v153
    v_cvt_pk_bf16_f32 v75, v154, v155
    v_mfma_f32_16x16x32_bf16 v[220:223], v[76:79], v[100:103], v[220:223]
    v_cvt_pk_bf16_f32 v76, v140, v141
    v_cvt_pk_bf16_f32 v77, v142, v143
    s_waitcnt lgkmcnt(10)
    v_mfma_f32_16x16x32_bf16 v[224:227], v[80:83], v[104:107], v[224:227]
    v_cvt_pk_bf16_f32 v78, v156, v157
    v_cvt_pk_bf16_f32 v79, v158, v159
    s_waitcnt lgkmcnt(9)
    v_mfma_f32_16x16x32_bf16 v[240:243], v[80:83], v[108:111], v[240:243]
    v_cvt_pk_bf16_f32 v80, v160, v161
    v_cvt_pk_bf16_f32 v81, v162, v163
    v_mfma_f32_16x16x32_bf16 v[228:231], v[84:87], v[104:107], v[228:231]
    v_cvt_pk_bf16_f32 v82, v176, v177
    v_cvt_pk_bf16_f32 v83, v178, v179
    v_mfma_f32_16x16x32_bf16 v[244:247], v[84:87], v[108:111], v[244:247]
    v_cvt_pk_bf16_f32 v84, v164, v165
    v_cvt_pk_bf16_f32 v85, v166, v167
    v_mfma_f32_16x16x32_bf16 v[232:235], v[88:91], v[104:107], v[232:235]
    v_cvt_pk_bf16_f32 v86, v180, v181
    v_cvt_pk_bf16_f32 v87, v182, v183
    v_mfma_f32_16x16x32_bf16 v[248:251], v[88:91], v[108:111], v[248:251]
    v_cvt_pk_bf16_f32 v88, v168, v169
    v_cvt_pk_bf16_f32 v89, v170, v171
    v_mfma_f32_16x16x32_bf16 v[236:239], v[92:95], v[104:107], v[236:239]
    v_cvt_pk_bf16_f32 v90, v184, v185
    v_cvt_pk_bf16_f32 v91, v186, v187
    v_mfma_f32_16x16x32_bf16 v[252:255], v[92:95], v[108:111], v[252:255]
    v_cvt_pk_bf16_f32 v92, v172, v173
    v_cvt_pk_bf16_f32 v93, v174, v175
    v_cvt_pk_bf16_f32 v94, v188, v189
    v_cvt_pk_bf16_f32 v95, v190, v191
    v_mfma_f32_16x16x32_bf16 v[128:131], v[16:19], v[32:35], 0
    ds_read_b64_tr_b16 v[48:49], v12 offset:8192
    s_waitcnt lgkmcnt(7)
    v_mfma_f32_16x16x32_bf16 v[132:135], v[16:19], v[36:39], 0
    ds_read_b64_tr_b16 v[50:51], v12 offset:9216
    s_waitcnt lgkmcnt(6)
    v_mfma_f32_16x16x32_bf16 v[136:139], v[16:19], v[40:43], 0
    ds_read_b64_tr_b16 v[52:53], v13 offset:8192
    s_waitcnt lgkmcnt(4)
    v_mfma_f32_16x16x32_bf16 v[140:143], v[16:19], v[44:47], 0
    ds_read_b128 v[16:19], v10 offset:0
    v_mfma_f32_16x16x32_bf16 v[144:147], v[20:23], v[32:35], 0
    ds_read_b64_tr_b16 v[54:55], v13 offset:9216
    v_mfma_f32_16x16x32_bf16 v[148:151], v[20:23], v[36:39], 0
    ds_read_b64_tr_b16 v[56:57], v14 offset:8192
    v_mfma_f32_16x16x32_bf16 v[152:155], v[20:23], v[40:43], 0
    ds_read_b64_tr_b16 v[58:59], v14 offset:9216
    v_mfma_f32_16x16x32_bf16 v[156:159], v[20:23], v[44:47], 0
    ds_read_b128 v[20:23], v10 offset:2048
    v_mfma_f32_16x16x32_bf16 v[160:163], v[24:27], v[32:35], 0
    ds_read_b64_tr_b16 v[60:61], v15 offset:8192
    v_mfma_f32_16x16x32_bf16 v[164:167], v[24:27], v[36:39], 0
    ds_read_b64_tr_b16 v[62:63], v15 offset:9216
    v_mfma_f32_16x16x32_bf16 v[168:171], v[24:27], v[40:43], 0
    v_mfma_f32_16x16x32_bf16 v[172:175], v[24:27], v[44:47], 0
    ds_read_b128 v[24:27], v11 offset:0
    s_waitcnt lgkmcnt(11)
    v_mfma_f32_16x16x32_bf16 v[176:179], v[28:31], v[32:35], 0
    v_mfma_f32_16x16x32_bf16 v[180:183], v[28:31], v[36:39], 0
    v_mfma_f32_16x16x32_bf16 v[184:187], v[28:31], v[40:43], 0
    v_mfma_f32_16x16x32_bf16 v[188:191], v[28:31], v[44:47], 0
    ds_read_b128 v[28:31], v11 offset:2048
    s_waitcnt lgkmcnt(8)
    v_mfma_f32_16x16x32_bf16 v[128:131], v[16:19], v[48:51], v[128:131]
    s_waitcnt lgkmcnt(7)
    v_mfma_f32_16x16x32_bf16 v[132:135], v[16:19], v[52:55], v[132:135]
    s_waitcnt lgkmcnt(5)
    v_mfma_f32_16x16x32_bf16 v[136:139], v[16:19], v[56:59], v[136:139]
    s_waitcnt lgkmcnt(2)
    v_mfma_f32_16x16x32_bf16 v[140:143], v[16:19], v[60:63], v[140:143]
    s_waitcnt lgkmcnt(0)
    s_barrier
    ds_read_b128 v[16:19], v8 offset:32768
    v_mfma_f32_16x16x32_bf16 v[144:147], v[20:23], v[48:51], v[144:147]
    ds_read_b64_tr_b16 v[32:33], v12 offset:32768
    v_mfma_f32_16x16x32_bf16 v[148:151], v[20:23], v[52:55], v[148:151]
    ds_read_b64_tr_b16 v[34:35], v12 offset:33792
    v_mfma_f32_16x16x32_bf16 v[152:155], v[20:23], v[56:59], v[152:155]
    ds_read_b64_tr_b16 v[36:37], v13 offset:32768
    v_mfma_f32_16x16x32_bf16 v[156:159], v[20:23], v[60:63], v[156:159]
    ds_read_b128 v[20:23], v8 offset:34816
    v_mfma_f32_16x16x32_bf16 v[160:163], v[24:27], v[48:51], v[160:163]
    ds_read_b64_tr_b16 v[38:39], v13 offset:33792
    v_mfma_f32_16x16x32_bf16 v[164:167], v[24:27], v[52:55], v[164:167]
    ds_read_b64_tr_b16 v[40:41], v14 offset:32768
    v_mfma_f32_16x16x32_bf16 v[168:171], v[24:27], v[56:59], v[168:171]
    ds_read_b64_tr_b16 v[42:43], v14 offset:33792
    v_mfma_f32_16x16x32_bf16 v[172:175], v[24:27], v[60:63], v[172:175]
    ds_read_b128 v[24:27], v9 offset:32768
    v_mfma_f32_16x16x32_bf16 v[176:179], v[28:31], v[48:51], v[176:179]
    ds_read_b64_tr_b16 v[44:45], v15 offset:32768
    v_mfma_f32_16x16x32_bf16 v[180:183], v[28:31], v[52:55], v[180:183]
    ds_read_b64_tr_b16 v[46:47], v15 offset:33792
    v_mfma_f32_16x16x32_bf16 v[184:187], v[28:31], v[56:59], v[184:187]
    v_mfma_f32_16x16x32_bf16 v[188:191], v[28:31], v[60:63], v[188:191]
    ds_read_b128 v[28:31], v9 offset:34816
    s_waitcnt lgkmcnt(9)
    v_mfma_f32_16x16x32_bf16 v[128:131], v[16:19], v[32:35], v[128:131]
    ds_read_b64_tr_b16 v[48:49], v12 offset:40960
    s_waitcnt lgkmcnt(7)
    v_mfma_f32_16x16x32_bf16 v[132:135], v[16:19], v[36:39], v[132:135]
    ds_read_b64_tr_b16 v[50:51], v12 offset:41984
    s_waitcnt lgkmcnt(6)
    v_mfma_f32_16x16x32_bf16 v[136:139], v[16:19], v[40:43], v[136:139]
    ds_read_b64_tr_b16 v[52:53], v13 offset:40960
    s_waitcnt lgkmcnt(4)
    v_mfma_f32_16x16x32_bf16 v[140:143], v[16:19], v[44:47], v[140:143]
    ds_read_b128 v[16:19], v10 offset:32768
    v_mfma_f32_16x16x32_bf16 v[144:147], v[20:23], v[32:35], v[144:147]
    ds_read_b64_tr_b16 v[54:55], v13 offset:41984
    v_mfma_f32_16x16x32_bf16 v[148:151], v[20:23], v[36:39], v[148:151]
    ds_read_b64_tr_b16 v[56:57], v14 offset:40960
    v_mfma_f32_16x16x32_bf16 v[152:155], v[20:23], v[40:43], v[152:155]
    ds_read_b64_tr_b16 v[58:59], v14 offset:41984
    v_mfma_f32_16x16x32_bf16 v[156:159], v[20:23], v[44:47], v[156:159]
    ds_read_b128 v[20:23], v10 offset:34816
    v_mfma_f32_16x16x32_bf16 v[160:163], v[24:27], v[32:35], v[160:163]
    ds_read_b64_tr_b16 v[60:61], v15 offset:40960
    v_mfma_f32_16x16x32_bf16 v[164:167], v[24:27], v[36:39], v[164:167]
    ds_read_b64_tr_b16 v[62:63], v15 offset:41984
    v_mfma_f32_16x16x32_bf16 v[168:171], v[24:27], v[40:43], v[168:171]
    v_add_u32 v8, 0x10000, v8
    v_add_u32 v9, 0x10000, v9
    v_mfma_f32_16x16x32_bf16 v[172:175], v[24:27], v[44:47], v[172:175]
    ds_read_b128 v[24:27], v11 offset:32768
    s_waitcnt lgkmcnt(11)
    v_mfma_f32_16x16x32_bf16 v[176:179], v[28:31], v[32:35], v[176:179]
    v_add_u32 v12, 0x10000, v12
    v_mfma_f32_16x16x32_bf16 v[180:183], v[28:31], v[36:39], v[180:183]
    v_add_u32 v13, 0x10000, v13
    v_mfma_f32_16x16x32_bf16 v[184:187], v[28:31], v[40:43], v[184:187]
    v_add_u32 v14, 0x10000, v14
    v_add_u32 v15, 0x10000, v15
    v_mfma_f32_16x16x32_bf16 v[188:191], v[28:31], v[44:47], v[188:191]
    ds_read_b128 v[28:31], v11 offset:34816
    s_waitcnt lgkmcnt(8)
    v_mfma_f32_16x16x32_bf16 v[128:131], v[16:19], v[48:51], v[128:131]
    v_add_u32 v10, 0x10000, v10
    s_waitcnt lgkmcnt(7)
    v_mfma_f32_16x16x32_bf16 v[132:135], v[16:19], v[52:55], v[132:135]
    v_add_u32 v11, 0x10000, v11
    s_waitcnt lgkmcnt(5)
    v_mfma_f32_16x16x32_bf16 v[136:139], v[16:19], v[56:59], v[136:139]
    s_waitcnt lgkmcnt(2)
    v_mfma_f32_16x16x32_bf16 v[140:143], v[16:19], v[60:63], v[140:143]
    s_waitcnt lgkmcnt(0)
    s_barrier
    ds_read_b128 v[16:19], v8 offset:0
    v_mfma_f32_16x16x32_bf16 v[144:147], v[20:23], v[48:51], v[144:147]
    ds_read_b64_tr_b16 v[32:33], v12 offset:0
    ds_read_b128 v[96:99], v119 offset:24576
    ds_read_b128 v[100:103], v120 offset:24576
    v_mfma_f32_16x16x32_bf16 v[148:151], v[20:23], v[52:55], v[148:151]
    ds_read_b64_tr_b16 v[34:35], v12 offset:1024
    ds_read_b128 v[104:107], v121 offset:24576
    ds_read_b128 v[108:111], v122 offset:24576
    v_mfma_f32_16x16x32_bf16 v[152:155], v[20:23], v[56:59], v[152:155]
    ds_read_b64_tr_b16 v[36:37], v13 offset:0
    v_mfma_f32_16x16x32_bf16 v[156:159], v[20:23], v[60:63], v[156:159]
    ds_read_b128 v[20:23], v8 offset:2048
    v_mfma_f32_16x16x32_bf16 v[160:163], v[24:27], v[48:51], v[160:163]
    ds_read_b64_tr_b16 v[38:39], v13 offset:1024
    v_mfma_f32_16x16x32_bf16 v[164:167], v[24:27], v[52:55], v[164:167]
    ds_read_b64_tr_b16 v[40:41], v14 offset:0
    v_mfma_f32_16x16x32_bf16 v[168:171], v[24:27], v[56:59], v[168:171]
    ds_read_b64_tr_b16 v[42:43], v14 offset:1024
    v_mfma_f32_16x16x32_bf16 v[172:175], v[24:27], v[60:63], v[172:175]
    ds_read_b128 v[24:27], v9 offset:0
    v_mfma_f32_16x16x32_bf16 v[176:179], v[28:31], v[48:51], v[176:179]
    ds_read_b64_tr_b16 v[44:45], v15 offset:0
    v_mfma_f32_16x16x32_bf16 v[180:183], v[28:31], v[52:55], v[180:183]
    ds_read_b64_tr_b16 v[46:47], v15 offset:1024
    v_mfma_f32_16x16x32_bf16 v[184:187], v[28:31], v[56:59], v[184:187]
    v_mfma_f32_16x16x32_bf16 v[188:191], v[28:31], v[60:63], v[188:191]
    ds_read_b128 v[28:31], v9 offset:2048
    s_waitcnt lgkmcnt(13)
    v_mfma_f32_16x16x32_bf16 v[192:195], v[64:67], v[96:99], v[192:195]
    s_waitcnt lgkmcnt(12)
    v_mfma_f32_16x16x32_bf16 v[208:211], v[64:67], v[100:103], v[208:211]
    v_cvt_pk_bf16_f32 v64, v128, v129
    v_cvt_pk_bf16_f32 v65, v130, v131
    v_mfma_f32_16x16x32_bf16 v[196:199], v[68:71], v[96:99], v[196:199]
    v_cvt_pk_bf16_f32 v66, v144, v145
    v_cvt_pk_bf16_f32 v67, v146, v147
    v_mfma_f32_16x16x32_bf16 v[212:215], v[68:71], v[100:103], v[212:215]
    v_cvt_pk_bf16_f32 v68, v132, v133
    v_cvt_pk_bf16_f32 v69, v134, v135
    v_mfma_f32_16x16x32_bf16 v[200:203], v[72:75], v[96:99], v[200:203]
    v_cvt_pk_bf16_f32 v70, v148, v149
    v_cvt_pk_bf16_f32 v71, v150, v151
    v_mfma_f32_16x16x32_bf16 v[216:219], v[72:75], v[100:103], v[216:219]
    v_cvt_pk_bf16_f32 v72, v136, v137
    v_cvt_pk_bf16_f32 v73, v138, v139
    v_mfma_f32_16x16x32_bf16 v[204:207], v[76:79], v[96:99], v[204:207]
    v_cvt_pk_bf16_f32 v74, v152, v153
    v_cvt_pk_bf16_f32 v75, v154, v155
    v_mfma_f32_16x16x32_bf16 v[220:223], v[76:79], v[100:103], v[220:223]
    v_cvt_pk_bf16_f32 v76, v140, v141
    v_cvt_pk_bf16_f32 v77, v142, v143
    s_waitcnt lgkmcnt(10)
    v_mfma_f32_16x16x32_bf16 v[224:227], v[80:83], v[104:107], v[224:227]
    v_cvt_pk_bf16_f32 v78, v156, v157
    v_cvt_pk_bf16_f32 v79, v158, v159
    s_waitcnt lgkmcnt(9)
    v_mfma_f32_16x16x32_bf16 v[240:243], v[80:83], v[108:111], v[240:243]
    v_cvt_pk_bf16_f32 v80, v160, v161
    v_cvt_pk_bf16_f32 v81, v162, v163
    v_mfma_f32_16x16x32_bf16 v[228:231], v[84:87], v[104:107], v[228:231]
    v_cvt_pk_bf16_f32 v82, v176, v177
    v_cvt_pk_bf16_f32 v83, v178, v179
    v_mfma_f32_16x16x32_bf16 v[244:247], v[84:87], v[108:111], v[244:247]
    v_cvt_pk_bf16_f32 v84, v164, v165
    v_cvt_pk_bf16_f32 v85, v166, v167
    v_mfma_f32_16x16x32_bf16 v[232:235], v[88:91], v[104:107], v[232:235]
    v_cvt_pk_bf16_f32 v86, v180, v181
    v_cvt_pk_bf16_f32 v87, v182, v183
    v_mfma_f32_16x16x32_bf16 v[248:251], v[88:91], v[108:111], v[248:251]
    v_cvt_pk_bf16_f32 v88, v168, v169
    v_cvt_pk_bf16_f32 v89, v170, v171
    v_mfma_f32_16x16x32_bf16 v[236:239], v[92:95], v[104:107], v[236:239]
    v_cvt_pk_bf16_f32 v90, v184, v185
    v_cvt_pk_bf16_f32 v91, v186, v187
    v_mfma_f32_16x16x32_bf16 v[252:255], v[92:95], v[108:111], v[252:255]
    v_cvt_pk_bf16_f32 v92, v172, v173
    v_cvt_pk_bf16_f32 v93, v174, v175
    v_cvt_pk_bf16_f32 v94, v188, v189
    v_cvt_pk_bf16_f32 v95, v190, v191
    v_mfma_f32_16x16x32_bf16 v[128:131], v[16:19], v[32:35], 0
    ds_read_b64_tr_b16 v[48:49], v12 offset:8192
    s_waitcnt lgkmcnt(7)
    v_mfma_f32_16x16x32_bf16 v[132:135], v[16:19], v[36:39], 0
    ds_read_b64_tr_b16 v[50:51], v12 offset:9216
    s_waitcnt lgkmcnt(6)
    v_mfma_f32_16x16x32_bf16 v[136:139], v[16:19], v[40:43], 0
    ds_read_b64_tr_b16 v[52:53], v13 offset:8192
    s_waitcnt lgkmcnt(4)
    v_mfma_f32_16x16x32_bf16 v[140:143], v[16:19], v[44:47], 0
    ds_read_b128 v[16:19], v10 offset:0
    v_mfma_f32_16x16x32_bf16 v[144:147], v[20:23], v[32:35], 0
    ds_read_b64_tr_b16 v[54:55], v13 offset:9216
    v_mfma_f32_16x16x32_bf16 v[148:151], v[20:23], v[36:39], 0
    ds_read_b64_tr_b16 v[56:57], v14 offset:8192
    v_mfma_f32_16x16x32_bf16 v[152:155], v[20:23], v[40:43], 0
    ds_read_b64_tr_b16 v[58:59], v14 offset:9216
    v_mfma_f32_16x16x32_bf16 v[156:159], v[20:23], v[44:47], 0
    ds_read_b128 v[20:23], v10 offset:2048
    v_mfma_f32_16x16x32_bf16 v[160:163], v[24:27], v[32:35], 0
    ds_read_b64_tr_b16 v[60:61], v15 offset:8192
    v_mfma_f32_16x16x32_bf16 v[164:167], v[24:27], v[36:39], 0
    ds_read_b64_tr_b16 v[62:63], v15 offset:9216
    v_mfma_f32_16x16x32_bf16 v[168:171], v[24:27], v[40:43], 0
    v_mfma_f32_16x16x32_bf16 v[172:175], v[24:27], v[44:47], 0
    ds_read_b128 v[24:27], v11 offset:0
    s_waitcnt lgkmcnt(11)
    v_mfma_f32_16x16x32_bf16 v[176:179], v[28:31], v[32:35], 0
    v_mfma_f32_16x16x32_bf16 v[180:183], v[28:31], v[36:39], 0
    v_mfma_f32_16x16x32_bf16 v[184:187], v[28:31], v[40:43], 0
    v_mfma_f32_16x16x32_bf16 v[188:191], v[28:31], v[44:47], 0
    ds_read_b128 v[28:31], v11 offset:2048
    s_waitcnt lgkmcnt(8)
    v_mfma_f32_16x16x32_bf16 v[128:131], v[16:19], v[48:51], v[128:131]
    s_waitcnt lgkmcnt(7)
    v_mfma_f32_16x16x32_bf16 v[132:135], v[16:19], v[52:55], v[132:135]
    s_waitcnt lgkmcnt(5)
    v_mfma_f32_16x16x32_bf16 v[136:139], v[16:19], v[56:59], v[136:139]
    s_waitcnt lgkmcnt(2)
    v_mfma_f32_16x16x32_bf16 v[140:143], v[16:19], v[60:63], v[140:143]
    s_waitcnt lgkmcnt(0)
    s_barrier
    ds_read_b128 v[16:19], v8 offset:32768
    v_mfma_f32_16x16x32_bf16 v[144:147], v[20:23], v[48:51], v[144:147]
    ds_read_b64_tr_b16 v[32:33], v12 offset:32768
    v_mfma_f32_16x16x32_bf16 v[148:151], v[20:23], v[52:55], v[148:151]
    ds_read_b64_tr_b16 v[34:35], v12 offset:33792
    v_mfma_f32_16x16x32_bf16 v[152:155], v[20:23], v[56:59], v[152:155]
    ds_read_b64_tr_b16 v[36:37], v13 offset:32768
    v_mfma_f32_16x16x32_bf16 v[156:159], v[20:23], v[60:63], v[156:159]
    ds_read_b128 v[20:23], v8 offset:34816
    v_mfma_f32_16x16x32_bf16 v[160:163], v[24:27], v[48:51], v[160:163]
    ds_read_b64_tr_b16 v[38:39], v13 offset:33792
    v_mfma_f32_16x16x32_bf16 v[164:167], v[24:27], v[52:55], v[164:167]
    ds_read_b64_tr_b16 v[40:41], v14 offset:32768
    v_mfma_f32_16x16x32_bf16 v[168:171], v[24:27], v[56:59], v[168:171]
    ds_read_b64_tr_b16 v[42:43], v14 offset:33792
    v_mfma_f32_16x16x32_bf16 v[172:175], v[24:27], v[60:63], v[172:175]
    ds_read_b128 v[24:27], v9 offset:32768
    v_mfma_f32_16x16x32_bf16 v[176:179], v[28:31], v[48:51], v[176:179]
    ds_read_b64_tr_b16 v[44:45], v15 offset:32768
    v_mfma_f32_16x16x32_bf16 v[180:183], v[28:31], v[52:55], v[180:183]
    ds_read_b64_tr_b16 v[46:47], v15 offset:33792
    v_mfma_f32_16x16x32_bf16 v[184:187], v[28:31], v[56:59], v[184:187]
    v_mfma_f32_16x16x32_bf16 v[188:191], v[28:31], v[60:63], v[188:191]
    ds_read_b128 v[28:31], v9 offset:34816
    s_waitcnt lgkmcnt(9)
    v_mfma_f32_16x16x32_bf16 v[128:131], v[16:19], v[32:35], v[128:131]
    ds_read_b64_tr_b16 v[48:49], v12 offset:40960
    s_waitcnt lgkmcnt(7)
    v_mfma_f32_16x16x32_bf16 v[132:135], v[16:19], v[36:39], v[132:135]
    ds_read_b64_tr_b16 v[50:51], v12 offset:41984
    s_waitcnt lgkmcnt(6)
    v_mfma_f32_16x16x32_bf16 v[136:139], v[16:19], v[40:43], v[136:139]
    ds_read_b64_tr_b16 v[52:53], v13 offset:40960
    s_waitcnt lgkmcnt(4)
    v_mfma_f32_16x16x32_bf16 v[140:143], v[16:19], v[44:47], v[140:143]
    ds_read_b128 v[16:19], v10 offset:32768
    v_mfma_f32_16x16x32_bf16 v[144:147], v[20:23], v[32:35], v[144:147]
    ds_read_b64_tr_b16 v[54:55], v13 offset:41984
    v_mfma_f32_16x16x32_bf16 v[148:151], v[20:23], v[36:39], v[148:151]
    ds_read_b64_tr_b16 v[56:57], v14 offset:40960
    v_mfma_f32_16x16x32_bf16 v[152:155], v[20:23], v[40:43], v[152:155]
    ds_read_b64_tr_b16 v[58:59], v14 offset:41984
    v_mfma_f32_16x16x32_bf16 v[156:159], v[20:23], v[44:47], v[156:159]
    ds_read_b128 v[20:23], v10 offset:34816
    v_mfma_f32_16x16x32_bf16 v[160:163], v[24:27], v[32:35], v[160:163]
    ds_read_b64_tr_b16 v[60:61], v15 offset:40960
    v_mfma_f32_16x16x32_bf16 v[164:167], v[24:27], v[36:39], v[164:167]
    ds_read_b64_tr_b16 v[62:63], v15 offset:41984
    v_mfma_f32_16x16x32_bf16 v[168:171], v[24:27], v[40:43], v[168:171]
    v_add_u32 v8, 0xffff0000, v8
    v_add_u32 v9, 0xffff0000, v9
    v_mfma_f32_16x16x32_bf16 v[172:175], v[24:27], v[44:47], v[172:175]
    ds_read_b128 v[24:27], v11 offset:32768
    s_waitcnt lgkmcnt(11)
    v_mfma_f32_16x16x32_bf16 v[176:179], v[28:31], v[32:35], v[176:179]
    v_add_u32 v12, 0xffff0000, v12
    v_mfma_f32_16x16x32_bf16 v[180:183], v[28:31], v[36:39], v[180:183]
    v_add_u32 v13, 0xffff0000, v13
    v_mfma_f32_16x16x32_bf16 v[184:187], v[28:31], v[40:43], v[184:187]
    v_add_u32 v14, 0xffff0000, v14
    v_add_u32 v15, 0xffff0000, v15
    v_mfma_f32_16x16x32_bf16 v[188:191], v[28:31], v[44:47], v[188:191]
    ds_read_b128 v[28:31], v11 offset:34816
    s_waitcnt lgkmcnt(8)
    v_mfma_f32_16x16x32_bf16 v[128:131], v[16:19], v[48:51], v[128:131]
    v_add_u32 v10, 0xffff0000, v10
    s_waitcnt lgkmcnt(7)
    v_mfma_f32_16x16x32_bf16 v[132:135], v[16:19], v[52:55], v[132:135]
    v_add_u32 v11, 0xffff0000, v11
    s_waitcnt lgkmcnt(5)
    v_mfma_f32_16x16x32_bf16 v[136:139], v[16:19], v[56:59], v[136:139]
    s_waitcnt lgkmcnt(2)
    v_mfma_f32_16x16x32_bf16 v[140:143], v[16:19], v[60:63], v[140:143]
    s_waitcnt lgkmcnt(0)
    s_barrier
    ds_read_b128 v[16:19], v8 offset:0
    v_mfma_f32_16x16x32_bf16 v[144:147], v[20:23], v[48:51], v[144:147]
    ds_read_b64_tr_b16 v[32:33], v12 offset:0
    ds_read_b128 v[96:99], v119 offset:0
    ds_read_b128 v[100:103], v120 offset:0
    v_mfma_f32_16x16x32_bf16 v[148:151], v[20:23], v[52:55], v[148:151]
    ds_read_b64_tr_b16 v[34:35], v12 offset:1024
    ds_read_b128 v[104:107], v121 offset:0
    ds_read_b128 v[108:111], v122 offset:0
    v_mfma_f32_16x16x32_bf16 v[152:155], v[20:23], v[56:59], v[152:155]
    ds_read_b64_tr_b16 v[36:37], v13 offset:0
    v_mfma_f32_16x16x32_bf16 v[156:159], v[20:23], v[60:63], v[156:159]
    ds_read_b128 v[20:23], v8 offset:2048
    v_mfma_f32_16x16x32_bf16 v[160:163], v[24:27], v[48:51], v[160:163]
    ds_read_b64_tr_b16 v[38:39], v13 offset:1024
    v_mfma_f32_16x16x32_bf16 v[164:167], v[24:27], v[52:55], v[164:167]
    ds_read_b64_tr_b16 v[40:41], v14 offset:0
    v_mfma_f32_16x16x32_bf16 v[168:171], v[24:27], v[56:59], v[168:171]
    ds_read_b64_tr_b16 v[42:43], v14 offset:1024
    v_mfma_f32_16x16x32_bf16 v[172:175], v[24:27], v[60:63], v[172:175]
    ds_read_b128 v[24:27], v9 offset:0
    v_mfma_f32_16x16x32_bf16 v[176:179], v[28:31], v[48:51], v[176:179]
    ds_read_b64_tr_b16 v[44:45], v15 offset:0
    v_mfma_f32_16x16x32_bf16 v[180:183], v[28:31], v[52:55], v[180:183]
    ds_read_b64_tr_b16 v[46:47], v15 offset:1024
    v_mfma_f32_16x16x32_bf16 v[184:187], v[28:31], v[56:59], v[184:187]
    v_mfma_f32_16x16x32_bf16 v[188:191], v[28:31], v[60:63], v[188:191]
    ds_read_b128 v[28:31], v9 offset:2048
    s_waitcnt lgkmcnt(13)
    v_mfma_f32_16x16x32_bf16 v[192:195], v[64:67], v[96:99], v[192:195]
    s_waitcnt lgkmcnt(12)
    v_mfma_f32_16x16x32_bf16 v[208:211], v[64:67], v[100:103], v[208:211]
    v_cvt_pk_bf16_f32 v64, v128, v129
    v_cvt_pk_bf16_f32 v65, v130, v131
    v_mfma_f32_16x16x32_bf16 v[196:199], v[68:71], v[96:99], v[196:199]
    v_cvt_pk_bf16_f32 v66, v144, v145
    v_cvt_pk_bf16_f32 v67, v146, v147
    v_mfma_f32_16x16x32_bf16 v[212:215], v[68:71], v[100:103], v[212:215]
    v_cvt_pk_bf16_f32 v68, v132, v133
    v_cvt_pk_bf16_f32 v69, v134, v135
    v_mfma_f32_16x16x32_bf16 v[200:203], v[72:75], v[96:99], v[200:203]
    v_cvt_pk_bf16_f32 v70, v148, v149
    v_cvt_pk_bf16_f32 v71, v150, v151
    v_mfma_f32_16x16x32_bf16 v[216:219], v[72:75], v[100:103], v[216:219]
    v_cvt_pk_bf16_f32 v72, v136, v137
    v_cvt_pk_bf16_f32 v73, v138, v139
    v_mfma_f32_16x16x32_bf16 v[204:207], v[76:79], v[96:99], v[204:207]
    v_cvt_pk_bf16_f32 v74, v152, v153
    v_cvt_pk_bf16_f32 v75, v154, v155
    v_mfma_f32_16x16x32_bf16 v[220:223], v[76:79], v[100:103], v[220:223]
    v_cvt_pk_bf16_f32 v76, v140, v141
    v_cvt_pk_bf16_f32 v77, v142, v143
    s_waitcnt lgkmcnt(10)
    v_mfma_f32_16x16x32_bf16 v[224:227], v[80:83], v[104:107], v[224:227]
    v_cvt_pk_bf16_f32 v78, v156, v157
    v_cvt_pk_bf16_f32 v79, v158, v159
    s_waitcnt lgkmcnt(9)
    v_mfma_f32_16x16x32_bf16 v[240:243], v[80:83], v[108:111], v[240:243]
    v_cvt_pk_bf16_f32 v80, v160, v161
    v_cvt_pk_bf16_f32 v81, v162, v163
    v_mfma_f32_16x16x32_bf16 v[228:231], v[84:87], v[104:107], v[228:231]
    v_cvt_pk_bf16_f32 v82, v176, v177
    v_cvt_pk_bf16_f32 v83, v178, v179
    v_mfma_f32_16x16x32_bf16 v[244:247], v[84:87], v[108:111], v[244:247]
    v_cvt_pk_bf16_f32 v84, v164, v165
    v_cvt_pk_bf16_f32 v85, v166, v167
    v_mfma_f32_16x16x32_bf16 v[232:235], v[88:91], v[104:107], v[232:235]
    v_cvt_pk_bf16_f32 v86, v180, v181
    v_cvt_pk_bf16_f32 v87, v182, v183
    v_mfma_f32_16x16x32_bf16 v[248:251], v[88:91], v[108:111], v[248:251]
    v_cvt_pk_bf16_f32 v88, v168, v169
    v_cvt_pk_bf16_f32 v89, v170, v171
    v_mfma_f32_16x16x32_bf16 v[236:239], v[92:95], v[104:107], v[236:239]
    v_cvt_pk_bf16_f32 v90, v184, v185
    v_cvt_pk_bf16_f32 v91, v186, v187
    v_mfma_f32_16x16x32_bf16 v[252:255], v[92:95], v[108:111], v[252:255]
    v_cvt_pk_bf16_f32 v92, v172, v173
    v_cvt_pk_bf16_f32 v93, v174, v175
    v_cvt_pk_bf16_f32 v94, v188, v189
    v_cvt_pk_bf16_f32 v95, v190, v191
    v_mfma_f32_16x16x32_bf16 v[128:131], v[16:19], v[32:35], 0
    ds_read_b64_tr_b16 v[48:49], v12 offset:8192
    s_waitcnt lgkmcnt(7)
    v_mfma_f32_16x16x32_bf16 v[132:135], v[16:19], v[36:39], 0
    ds_read_b64_tr_b16 v[50:51], v12 offset:9216
    s_waitcnt lgkmcnt(6)
    v_mfma_f32_16x16x32_bf16 v[136:139], v[16:19], v[40:43], 0
    ds_read_b64_tr_b16 v[52:53], v13 offset:8192
    s_waitcnt lgkmcnt(4)
    v_mfma_f32_16x16x32_bf16 v[140:143], v[16:19], v[44:47], 0
    ds_read_b128 v[16:19], v10 offset:0
    v_mfma_f32_16x16x32_bf16 v[144:147], v[20:23], v[32:35], 0
    ds_read_b64_tr_b16 v[54:55], v13 offset:9216
    v_mfma_f32_16x16x32_bf16 v[148:151], v[20:23], v[36:39], 0
    ds_read_b64_tr_b16 v[56:57], v14 offset:8192
    v_mfma_f32_16x16x32_bf16 v[152:155], v[20:23], v[40:43], 0
    ds_read_b64_tr_b16 v[58:59], v14 offset:9216
    v_mfma_f32_16x16x32_bf16 v[156:159], v[20:23], v[44:47], 0
    ds_read_b128 v[20:23], v10 offset:2048
    v_mfma_f32_16x16x32_bf16 v[160:163], v[24:27], v[32:35], 0
    ds_read_b64_tr_b16 v[60:61], v15 offset:8192
    v_mfma_f32_16x16x32_bf16 v[164:167], v[24:27], v[36:39], 0
    ds_read_b64_tr_b16 v[62:63], v15 offset:9216
    v_mfma_f32_16x16x32_bf16 v[168:171], v[24:27], v[40:43], 0
    v_mfma_f32_16x16x32_bf16 v[172:175], v[24:27], v[44:47], 0
    ds_read_b128 v[24:27], v11 offset:0
    s_waitcnt lgkmcnt(11)
    v_mfma_f32_16x16x32_bf16 v[176:179], v[28:31], v[32:35], 0
    v_mfma_f32_16x16x32_bf16 v[180:183], v[28:31], v[36:39], 0
    v_mfma_f32_16x16x32_bf16 v[184:187], v[28:31], v[40:43], 0
    v_mfma_f32_16x16x32_bf16 v[188:191], v[28:31], v[44:47], 0
    ds_read_b128 v[28:31], v11 offset:2048
    s_waitcnt lgkmcnt(8)
    v_mfma_f32_16x16x32_bf16 v[128:131], v[16:19], v[48:51], v[128:131]
    s_waitcnt lgkmcnt(7)
    v_mfma_f32_16x16x32_bf16 v[132:135], v[16:19], v[52:55], v[132:135]
    s_waitcnt lgkmcnt(5)
    v_mfma_f32_16x16x32_bf16 v[136:139], v[16:19], v[56:59], v[136:139]
    s_waitcnt lgkmcnt(2)
    v_mfma_f32_16x16x32_bf16 v[140:143], v[16:19], v[60:63], v[140:143]
    s_waitcnt lgkmcnt(0)
    s_barrier
    ds_read_b128 v[16:19], v8 offset:32768
    v_mfma_f32_16x16x32_bf16 v[144:147], v[20:23], v[48:51], v[144:147]
    ds_read_b64_tr_b16 v[32:33], v12 offset:32768
    v_mfma_f32_16x16x32_bf16 v[148:151], v[20:23], v[52:55], v[148:151]
    ds_read_b64_tr_b16 v[34:35], v12 offset:33792
    v_mfma_f32_16x16x32_bf16 v[152:155], v[20:23], v[56:59], v[152:155]
    ds_read_b64_tr_b16 v[36:37], v13 offset:32768
    v_mfma_f32_16x16x32_bf16 v[156:159], v[20:23], v[60:63], v[156:159]
    ds_read_b128 v[20:23], v8 offset:34816
    v_mfma_f32_16x16x32_bf16 v[160:163], v[24:27], v[48:51], v[160:163]
    ds_read_b64_tr_b16 v[38:39], v13 offset:33792
    v_mfma_f32_16x16x32_bf16 v[164:167], v[24:27], v[52:55], v[164:167]
    ds_read_b64_tr_b16 v[40:41], v14 offset:32768
    v_mfma_f32_16x16x32_bf16 v[168:171], v[24:27], v[56:59], v[168:171]
    ds_read_b64_tr_b16 v[42:43], v14 offset:33792
    v_mfma_f32_16x16x32_bf16 v[172:175], v[24:27], v[60:63], v[172:175]
    ds_read_b128 v[24:27], v9 offset:32768
    v_mfma_f32_16x16x32_bf16 v[176:179], v[28:31], v[48:51], v[176:179]
    ds_read_b64_tr_b16 v[44:45], v15 offset:32768
    v_mfma_f32_16x16x32_bf16 v[180:183], v[28:31], v[52:55], v[180:183]
    ds_read_b64_tr_b16 v[46:47], v15 offset:33792
    v_mfma_f32_16x16x32_bf16 v[184:187], v[28:31], v[56:59], v[184:187]
    v_mfma_f32_16x16x32_bf16 v[188:191], v[28:31], v[60:63], v[188:191]
    ds_read_b128 v[28:31], v9 offset:34816
    s_waitcnt lgkmcnt(9)
    v_mfma_f32_16x16x32_bf16 v[128:131], v[16:19], v[32:35], v[128:131]
    ds_read_b64_tr_b16 v[48:49], v12 offset:40960
    s_waitcnt lgkmcnt(7)
    v_mfma_f32_16x16x32_bf16 v[132:135], v[16:19], v[36:39], v[132:135]
    ds_read_b64_tr_b16 v[50:51], v12 offset:41984
    s_waitcnt lgkmcnt(6)
    v_mfma_f32_16x16x32_bf16 v[136:139], v[16:19], v[40:43], v[136:139]
    ds_read_b64_tr_b16 v[52:53], v13 offset:40960
    s_waitcnt lgkmcnt(4)
    v_mfma_f32_16x16x32_bf16 v[140:143], v[16:19], v[44:47], v[140:143]
    ds_read_b128 v[16:19], v10 offset:32768
    v_mfma_f32_16x16x32_bf16 v[144:147], v[20:23], v[32:35], v[144:147]
    ds_read_b64_tr_b16 v[54:55], v13 offset:41984
    v_mfma_f32_16x16x32_bf16 v[148:151], v[20:23], v[36:39], v[148:151]
    ds_read_b64_tr_b16 v[56:57], v14 offset:40960
    v_mfma_f32_16x16x32_bf16 v[152:155], v[20:23], v[40:43], v[152:155]
    ds_read_b64_tr_b16 v[58:59], v14 offset:41984
    v_mfma_f32_16x16x32_bf16 v[156:159], v[20:23], v[44:47], v[156:159]
    ds_read_b128 v[20:23], v10 offset:34816
    v_mfma_f32_16x16x32_bf16 v[160:163], v[24:27], v[32:35], v[160:163]
    ds_read_b64_tr_b16 v[60:61], v15 offset:40960
    v_mfma_f32_16x16x32_bf16 v[164:167], v[24:27], v[36:39], v[164:167]
    ds_read_b64_tr_b16 v[62:63], v15 offset:41984
    v_mfma_f32_16x16x32_bf16 v[168:171], v[24:27], v[40:43], v[168:171]
    v_add_u32 v8, 0x10000, v8
    v_add_u32 v9, 0x10000, v9
    v_mfma_f32_16x16x32_bf16 v[172:175], v[24:27], v[44:47], v[172:175]
    ds_read_b128 v[24:27], v11 offset:32768
    s_waitcnt lgkmcnt(11)
    v_mfma_f32_16x16x32_bf16 v[176:179], v[28:31], v[32:35], v[176:179]
    v_add_u32 v12, 0x10000, v12
    v_mfma_f32_16x16x32_bf16 v[180:183], v[28:31], v[36:39], v[180:183]
    v_add_u32 v13, 0x10000, v13
    v_mfma_f32_16x16x32_bf16 v[184:187], v[28:31], v[40:43], v[184:187]
    v_add_u32 v14, 0x10000, v14
    v_add_u32 v15, 0x10000, v15
    v_mfma_f32_16x16x32_bf16 v[188:191], v[28:31], v[44:47], v[188:191]
    ds_read_b128 v[28:31], v11 offset:34816
    s_waitcnt lgkmcnt(8)
    v_mfma_f32_16x16x32_bf16 v[128:131], v[16:19], v[48:51], v[128:131]
    v_add_u32 v10, 0x10000, v10
    s_waitcnt lgkmcnt(7)
    v_mfma_f32_16x16x32_bf16 v[132:135], v[16:19], v[52:55], v[132:135]
    v_add_u32 v11, 0x10000, v11
    s_waitcnt lgkmcnt(5)
    v_mfma_f32_16x16x32_bf16 v[136:139], v[16:19], v[56:59], v[136:139]
    s_waitcnt lgkmcnt(2)
    v_mfma_f32_16x16x32_bf16 v[140:143], v[16:19], v[60:63], v[140:143]
    s_waitcnt lgkmcnt(0)
    s_barrier
    ds_read_b128 v[16:19], v8 offset:0
    v_mfma_f32_16x16x32_bf16 v[144:147], v[20:23], v[48:51], v[144:147]
    ds_read_b64_tr_b16 v[32:33], v12 offset:0
    ds_read_b128 v[96:99], v119 offset:8192
    ds_read_b128 v[100:103], v120 offset:8192
    v_mfma_f32_16x16x32_bf16 v[148:151], v[20:23], v[52:55], v[148:151]
    ds_read_b64_tr_b16 v[34:35], v12 offset:1024
    ds_read_b128 v[104:107], v121 offset:8192
    ds_read_b128 v[108:111], v122 offset:8192
    v_mfma_f32_16x16x32_bf16 v[152:155], v[20:23], v[56:59], v[152:155]
    ds_read_b64_tr_b16 v[36:37], v13 offset:0
    v_mfma_f32_16x16x32_bf16 v[156:159], v[20:23], v[60:63], v[156:159]
    ds_read_b128 v[20:23], v8 offset:2048
    v_mfma_f32_16x16x32_bf16 v[160:163], v[24:27], v[48:51], v[160:163]
    ds_read_b64_tr_b16 v[38:39], v13 offset:1024
    v_mfma_f32_16x16x32_bf16 v[164:167], v[24:27], v[52:55], v[164:167]
    ds_read_b64_tr_b16 v[40:41], v14 offset:0
    v_mfma_f32_16x16x32_bf16 v[168:171], v[24:27], v[56:59], v[168:171]
    ds_read_b64_tr_b16 v[42:43], v14 offset:1024
    v_mfma_f32_16x16x32_bf16 v[172:175], v[24:27], v[60:63], v[172:175]
    ds_read_b128 v[24:27], v9 offset:0
    v_mfma_f32_16x16x32_bf16 v[176:179], v[28:31], v[48:51], v[176:179]
    ds_read_b64_tr_b16 v[44:45], v15 offset:0
    v_mfma_f32_16x16x32_bf16 v[180:183], v[28:31], v[52:55], v[180:183]
    ds_read_b64_tr_b16 v[46:47], v15 offset:1024
    v_mfma_f32_16x16x32_bf16 v[184:187], v[28:31], v[56:59], v[184:187]
    v_mfma_f32_16x16x32_bf16 v[188:191], v[28:31], v[60:63], v[188:191]
    ds_read_b128 v[28:31], v9 offset:2048
    s_waitcnt lgkmcnt(13)
    v_mfma_f32_16x16x32_bf16 v[192:195], v[64:67], v[96:99], v[192:195]
    s_waitcnt lgkmcnt(12)
    v_mfma_f32_16x16x32_bf16 v[208:211], v[64:67], v[100:103], v[208:211]
    v_cvt_pk_bf16_f32 v64, v128, v129
    v_cvt_pk_bf16_f32 v65, v130, v131
    v_mfma_f32_16x16x32_bf16 v[196:199], v[68:71], v[96:99], v[196:199]
    v_cvt_pk_bf16_f32 v66, v144, v145
    v_cvt_pk_bf16_f32 v67, v146, v147
    v_mfma_f32_16x16x32_bf16 v[212:215], v[68:71], v[100:103], v[212:215]
    v_cvt_pk_bf16_f32 v68, v132, v133
    v_cvt_pk_bf16_f32 v69, v134, v135
    v_mfma_f32_16x16x32_bf16 v[200:203], v[72:75], v[96:99], v[200:203]
    v_cvt_pk_bf16_f32 v70, v148, v149
    v_cvt_pk_bf16_f32 v71, v150, v151
    v_mfma_f32_16x16x32_bf16 v[216:219], v[72:75], v[100:103], v[216:219]
    v_cvt_pk_bf16_f32 v72, v136, v137
    v_cvt_pk_bf16_f32 v73, v138, v139
    v_mfma_f32_16x16x32_bf16 v[204:207], v[76:79], v[96:99], v[204:207]
    v_cvt_pk_bf16_f32 v74, v152, v153
    v_cvt_pk_bf16_f32 v75, v154, v155
    v_mfma_f32_16x16x32_bf16 v[220:223], v[76:79], v[100:103], v[220:223]
    v_cvt_pk_bf16_f32 v76, v140, v141
    v_cvt_pk_bf16_f32 v77, v142, v143
    s_waitcnt lgkmcnt(10)
    v_mfma_f32_16x16x32_bf16 v[224:227], v[80:83], v[104:107], v[224:227]
    v_cvt_pk_bf16_f32 v78, v156, v157
    v_cvt_pk_bf16_f32 v79, v158, v159
    s_waitcnt lgkmcnt(9)
    v_mfma_f32_16x16x32_bf16 v[240:243], v[80:83], v[108:111], v[240:243]
    v_cvt_pk_bf16_f32 v80, v160, v161
    v_cvt_pk_bf16_f32 v81, v162, v163
    v_mfma_f32_16x16x32_bf16 v[228:231], v[84:87], v[104:107], v[228:231]
    v_cvt_pk_bf16_f32 v82, v176, v177
    v_cvt_pk_bf16_f32 v83, v178, v179
    v_mfma_f32_16x16x32_bf16 v[244:247], v[84:87], v[108:111], v[244:247]
    v_cvt_pk_bf16_f32 v84, v164, v165
    v_cvt_pk_bf16_f32 v85, v166, v167
    v_mfma_f32_16x16x32_bf16 v[232:235], v[88:91], v[104:107], v[232:235]
    v_cvt_pk_bf16_f32 v86, v180, v181
    v_cvt_pk_bf16_f32 v87, v182, v183
    v_mfma_f32_16x16x32_bf16 v[248:251], v[88:91], v[108:111], v[248:251]
    v_cvt_pk_bf16_f32 v88, v168, v169
    v_cvt_pk_bf16_f32 v89, v170, v171
    v_mfma_f32_16x16x32_bf16 v[236:239], v[92:95], v[104:107], v[236:239]
    v_cvt_pk_bf16_f32 v90, v184, v185
    v_cvt_pk_bf16_f32 v91, v186, v187
    v_mfma_f32_16x16x32_bf16 v[252:255], v[92:95], v[108:111], v[252:255]
    v_cvt_pk_bf16_f32 v92, v172, v173
    v_cvt_pk_bf16_f32 v93, v174, v175
    v_cvt_pk_bf16_f32 v94, v188, v189
    v_cvt_pk_bf16_f32 v95, v190, v191
    v_mfma_f32_16x16x32_bf16 v[128:131], v[16:19], v[32:35], 0
    ds_read_b64_tr_b16 v[48:49], v12 offset:8192
    s_waitcnt lgkmcnt(7)
    v_mfma_f32_16x16x32_bf16 v[132:135], v[16:19], v[36:39], 0
    ds_read_b64_tr_b16 v[50:51], v12 offset:9216
    s_waitcnt lgkmcnt(6)
    v_mfma_f32_16x16x32_bf16 v[136:139], v[16:19], v[40:43], 0
    ds_read_b64_tr_b16 v[52:53], v13 offset:8192
    s_waitcnt lgkmcnt(4)
    v_mfma_f32_16x16x32_bf16 v[140:143], v[16:19], v[44:47], 0
    ds_read_b128 v[16:19], v10 offset:0
    v_lshlrev_b32 v6, 2, v0
    v_mfma_f32_16x16x32_bf16 v[144:147], v[20:23], v[32:35], 0
    ds_read_b64_tr_b16 v[54:55], v13 offset:9216
    s_lshl_b32 s40, s38, 5
    v_mfma_f32_16x16x32_bf16 v[148:151], v[20:23], v[36:39], 0
    ds_read_b64_tr_b16 v[56:57], v14 offset:8192
    s_add_u32 s40, s40, s6
    v_mfma_f32_16x16x32_bf16 v[152:155], v[20:23], v[40:43], 0
    ds_read_b64_tr_b16 v[58:59], v14 offset:9216
    s_lshl_b32 s41, s4, 2
    v_mfma_f32_16x16x32_bf16 v[156:159], v[20:23], v[44:47], 0
    ds_read_b128 v[20:23], v10 offset:2048
    v_mfma_f32_16x16x32_bf16 v[160:163], v[24:27], v[32:35], 0
    ds_read_b64_tr_b16 v[60:61], v15 offset:8192
    s_add_u32 s41, s41, s7
    v_mfma_f32_16x16x32_bf16 v[164:167], v[24:27], v[36:39], 0
    ds_read_b64_tr_b16 v[62:63], v15 offset:9216
    s_lshl_b32 s43, s41, 11
    v_mfma_f32_16x16x32_bf16 v[168:171], v[24:27], v[40:43], 0
    s_add_u32 s43, s43, 0x400000
    s_xor_b32 s42, s4, 1
    v_mfma_f32_16x16x32_bf16 v[172:175], v[24:27], v[44:47], 0
    ds_read_b128 v[24:27], v11 offset:0
    s_waitcnt lgkmcnt(11)
    v_mfma_f32_16x16x32_bf16 v[176:179], v[28:31], v[32:35], 0
    s_lshl_b32 s42, s42, 3
    s_add_u32 s42, s42, s40
    v_mfma_f32_16x16x32_bf16 v[180:183], v[28:31], v[36:39], 0
    s_lshl_b32 s53, s42, 11
    s_lshl_b32 s42, s42, 15
    v_mfma_f32_16x16x32_bf16 v[184:187], v[28:31], v[40:43], 0
    s_add_u32 s45, s42, s43
    s_xor_b32 s42, s4, 2
    v_mfma_f32_16x16x32_bf16 v[188:191], v[28:31], v[44:47], 0
    ds_read_b128 v[28:31], v11 offset:2048
    s_waitcnt lgkmcnt(8)
    v_mfma_f32_16x16x32_bf16 v[128:131], v[16:19], v[48:51], v[128:131]
    s_lshl_b32 s42, s42, 3
    s_waitcnt lgkmcnt(7)
    v_mfma_f32_16x16x32_bf16 v[132:135], v[16:19], v[52:55], v[132:135]
    s_add_u32 s42, s42, s40
    s_waitcnt lgkmcnt(5)
    v_mfma_f32_16x16x32_bf16 v[136:139], v[16:19], v[56:59], v[136:139]
    s_lshl_b32 s54, s42, 11
    s_waitcnt lgkmcnt(2)
    v_mfma_f32_16x16x32_bf16 v[140:143], v[16:19], v[60:63], v[140:143]
    s_waitcnt lgkmcnt(0)
    s_barrier
    ds_read_b128 v[16:19], v8 offset:32768
    v_mfma_f32_16x16x32_bf16 v[144:147], v[20:23], v[48:51], v[144:147]
    ds_read_b64_tr_b16 v[32:33], v12 offset:32768
    s_lshl_b32 s42, s42, 15
    v_mfma_f32_16x16x32_bf16 v[148:151], v[20:23], v[52:55], v[148:151]
    ds_read_b64_tr_b16 v[34:35], v12 offset:33792
    s_add_u32 s46, s42, s43
    v_mfma_f32_16x16x32_bf16 v[152:155], v[20:23], v[56:59], v[152:155]
    ds_read_b64_tr_b16 v[36:37], v13 offset:32768
    s_xor_b32 s42, s4, 3
    v_mfma_f32_16x16x32_bf16 v[156:159], v[20:23], v[60:63], v[156:159]
    ds_read_b128 v[20:23], v8 offset:34816
    v_mfma_f32_16x16x32_bf16 v[160:163], v[24:27], v[48:51], v[160:163]
    ds_read_b64_tr_b16 v[38:39], v13 offset:33792
    s_lshl_b32 s42, s42, 3
    v_mfma_f32_16x16x32_bf16 v[164:167], v[24:27], v[52:55], v[164:167]
    ds_read_b64_tr_b16 v[40:41], v14 offset:32768
    s_add_u32 s42, s42, s40
    v_mfma_f32_16x16x32_bf16 v[168:171], v[24:27], v[56:59], v[168:171]
    ds_read_b64_tr_b16 v[42:43], v14 offset:33792
    s_lshl_b32 s55, s42, 11
    v_mfma_f32_16x16x32_bf16 v[172:175], v[24:27], v[60:63], v[172:175]
    ds_read_b128 v[24:27], v9 offset:32768
    v_mfma_f32_16x16x32_bf16 v[176:179], v[28:31], v[48:51], v[176:179]
    ds_read_b64_tr_b16 v[44:45], v15 offset:32768
    s_lshl_b32 s42, s42, 15
    v_mfma_f32_16x16x32_bf16 v[180:183], v[28:31], v[52:55], v[180:183]
    ds_read_b64_tr_b16 v[46:47], v15 offset:33792
    s_add_u32 s47, s42, s43
    v_mfma_f32_16x16x32_bf16 v[184:187], v[28:31], v[56:59], v[184:187]
    s_lshl_b32 s43, s41, 7
    s_add_u32 s43, s43, 0x10000
    v_mfma_f32_16x16x32_bf16 v[188:191], v[28:31], v[60:63], v[188:191]
    ds_read_b128 v[28:31], v9 offset:34816
    s_waitcnt lgkmcnt(9)
    v_mfma_f32_16x16x32_bf16 v[128:131], v[16:19], v[32:35], v[128:131]
    ds_read_b64_tr_b16 v[48:49], v12 offset:40960
    s_waitcnt lgkmcnt(7)
    v_mfma_f32_16x16x32_bf16 v[132:135], v[16:19], v[36:39], v[132:135]
    ds_read_b64_tr_b16 v[50:51], v12 offset:41984
    s_waitcnt lgkmcnt(6)
    v_mfma_f32_16x16x32_bf16 v[136:139], v[16:19], v[40:43], v[136:139]
    ds_read_b64_tr_b16 v[52:53], v13 offset:40960
    s_waitcnt lgkmcnt(4)
    v_mfma_f32_16x16x32_bf16 v[140:143], v[16:19], v[44:47], v[140:143]
    ds_read_b128 v[16:19], v10 offset:32768
    s_add_u32 s53, s53, s43
    v_mfma_f32_16x16x32_bf16 v[144:147], v[20:23], v[32:35], v[144:147]
    ds_read_b64_tr_b16 v[54:55], v13 offset:41984
    s_add_u32 s54, s54, s43
    v_mfma_f32_16x16x32_bf16 v[148:151], v[20:23], v[36:39], v[148:151]
    ds_read_b64_tr_b16 v[56:57], v14 offset:40960
    s_add_u32 s55, s55, s43
    v_mfma_f32_16x16x32_bf16 v[152:155], v[20:23], v[40:43], v[152:155]
    ds_read_b64_tr_b16 v[58:59], v14 offset:41984
    v_mfma_f32_16x16x32_bf16 v[156:159], v[20:23], v[44:47], v[156:159]
    ds_read_b128 v[20:23], v10 offset:34816
    v_mfma_f32_16x16x32_bf16 v[160:163], v[24:27], v[32:35], v[160:163]
    ds_read_b64_tr_b16 v[60:61], v15 offset:40960
    v_mfma_f32_16x16x32_bf16 v[164:167], v[24:27], v[36:39], v[164:167]
    ds_read_b64_tr_b16 v[62:63], v15 offset:41984
    v_mfma_f32_16x16x32_bf16 v[168:171], v[24:27], v[40:43], v[168:171]
    v_mfma_f32_16x16x32_bf16 v[172:175], v[24:27], v[44:47], v[172:175]
    ds_read_b128 v[24:27], v11 offset:32768
    s_waitcnt lgkmcnt(11)
    v_mfma_f32_16x16x32_bf16 v[176:179], v[28:31], v[32:35], v[176:179]
    v_mfma_f32_16x16x32_bf16 v[180:183], v[28:31], v[36:39], v[180:183]
    v_mfma_f32_16x16x32_bf16 v[184:187], v[28:31], v[40:43], v[184:187]
    v_mfma_f32_16x16x32_bf16 v[188:191], v[28:31], v[44:47], v[188:191]
    ds_read_b128 v[28:31], v11 offset:34816
    s_waitcnt lgkmcnt(8)
    v_mfma_f32_16x16x32_bf16 v[128:131], v[16:19], v[48:51], v[128:131]
    s_waitcnt lgkmcnt(7)
    v_mfma_f32_16x16x32_bf16 v[132:135], v[16:19], v[52:55], v[132:135]
    s_waitcnt lgkmcnt(5)
    v_mfma_f32_16x16x32_bf16 v[136:139], v[16:19], v[56:59], v[136:139]
    s_waitcnt lgkmcnt(2)
    v_mfma_f32_16x16x32_bf16 v[140:143], v[16:19], v[60:63], v[140:143]
    v_mfma_f32_16x16x32_bf16 v[144:147], v[20:23], v[48:51], v[144:147]
    ds_read_b128 v[96:99], v119 offset:16384
    v_mfma_f32_16x16x32_bf16 v[148:151], v[20:23], v[52:55], v[148:151]
    ds_read_b128 v[100:103], v120 offset:16384
    v_mfma_f32_16x16x32_bf16 v[152:155], v[20:23], v[56:59], v[152:155]
    ds_read_b128 v[104:107], v121 offset:16384
    v_mfma_f32_16x16x32_bf16 v[156:159], v[20:23], v[60:63], v[156:159]
    ds_read_b128 v[108:111], v122 offset:16384
    s_waitcnt lgkmcnt(5)
    v_mfma_f32_16x16x32_bf16 v[160:163], v[24:27], v[48:51], v[160:163]
    ds_read_b128 v[32:35], v119 offset:24576
    v_mfma_f32_16x16x32_bf16 v[164:167], v[24:27], v[52:55], v[164:167]
    ds_read_b128 v[36:39], v120 offset:24576
    v_mfma_f32_16x16x32_bf16 v[168:171], v[24:27], v[56:59], v[168:171]
    ds_read_b128 v[40:43], v121 offset:24576
    v_mfma_f32_16x16x32_bf16 v[172:175], v[24:27], v[60:63], v[172:175]
    ds_read_b128 v[44:47], v122 offset:24576
    s_waitcnt lgkmcnt(8)
    v_mfma_f32_16x16x32_bf16 v[176:179], v[28:31], v[48:51], v[176:179]
    v_mfma_f32_16x16x32_bf16 v[180:183], v[28:31], v[52:55], v[180:183]
    v_mfma_f32_16x16x32_bf16 v[184:187], v[28:31], v[56:59], v[184:187]
    v_mfma_f32_16x16x32_bf16 v[188:191], v[28:31], v[60:63], v[188:191]
    s_waitcnt lgkmcnt(7)
    v_mfma_f32_16x16x32_bf16 v[192:195], v[64:67], v[96:99], v[192:195]
    s_waitcnt lgkmcnt(6)
    v_mfma_f32_16x16x32_bf16 v[208:211], v[64:67], v[100:103], v[208:211]
    v_cvt_pk_bf16_f32 v64, v128, v129
    v_cvt_pk_bf16_f32 v65, v130, v131
    v_mfma_f32_16x16x32_bf16 v[196:199], v[68:71], v[96:99], v[196:199]
    v_cvt_pk_bf16_f32 v66, v144, v145
    v_cvt_pk_bf16_f32 v67, v146, v147
    v_mfma_f32_16x16x32_bf16 v[212:215], v[68:71], v[100:103], v[212:215]
    v_cvt_pk_bf16_f32 v68, v132, v133
    v_cvt_pk_bf16_f32 v69, v134, v135
    v_mfma_f32_16x16x32_bf16 v[200:203], v[72:75], v[96:99], v[200:203]
    v_cvt_pk_bf16_f32 v70, v148, v149
    v_cvt_pk_bf16_f32 v71, v150, v151
    v_mfma_f32_16x16x32_bf16 v[216:219], v[72:75], v[100:103], v[216:219]
    v_cvt_pk_bf16_f32 v72, v136, v137
    v_cvt_pk_bf16_f32 v73, v138, v139
    v_mfma_f32_16x16x32_bf16 v[204:207], v[76:79], v[96:99], v[204:207]
    v_cvt_pk_bf16_f32 v74, v152, v153
    v_cvt_pk_bf16_f32 v75, v154, v155
    v_mfma_f32_16x16x32_bf16 v[220:223], v[76:79], v[100:103], v[220:223]
    v_cvt_pk_bf16_f32 v76, v140, v141
    v_cvt_pk_bf16_f32 v77, v142, v143
    s_waitcnt lgkmcnt(5)
    v_mfma_f32_16x16x32_bf16 v[224:227], v[80:83], v[104:107], v[224:227]
    v_cvt_pk_bf16_f32 v78, v156, v157
    v_cvt_pk_bf16_f32 v79, v158, v159
    s_waitcnt lgkmcnt(4)
    v_mfma_f32_16x16x32_bf16 v[240:243], v[80:83], v[108:111], v[240:243]
    v_cvt_pk_bf16_f32 v80, v160, v161
    v_cvt_pk_bf16_f32 v81, v162, v163
    v_mfma_f32_16x16x32_bf16 v[228:231], v[84:87], v[104:107], v[228:231]
    v_cvt_pk_bf16_f32 v82, v176, v177
    v_cvt_pk_bf16_f32 v83, v178, v179
    v_mfma_f32_16x16x32_bf16 v[244:247], v[84:87], v[108:111], v[244:247]
    v_cvt_pk_bf16_f32 v84, v164, v165
    v_cvt_pk_bf16_f32 v85, v166, v167
    v_mfma_f32_16x16x32_bf16 v[232:235], v[88:91], v[104:107], v[232:235]
    v_cvt_pk_bf16_f32 v86, v180, v181
    v_cvt_pk_bf16_f32 v87, v182, v183
    v_mfma_f32_16x16x32_bf16 v[248:251], v[88:91], v[108:111], v[248:251]
    v_cvt_pk_bf16_f32 v88, v168, v169
    v_cvt_pk_bf16_f32 v89, v170, v171
    v_mfma_f32_16x16x32_bf16 v[236:239], v[92:95], v[104:107], v[236:239]
    v_cvt_pk_bf16_f32 v90, v184, v185
    v_cvt_pk_bf16_f32 v91, v186, v187
    v_mfma_f32_16x16x32_bf16 v[252:255], v[92:95], v[108:111], v[252:255]
    v_cvt_pk_bf16_f32 v92, v172, v173
    v_cvt_pk_bf16_f32 v93, v174, v175
    v_cvt_pk_bf16_f32 v94, v188, v189
    v_cvt_pk_bf16_f32 v95, v190, v191
    s_waitcnt lgkmcnt(2)
    v_mfma_f32_16x16x32_bf16 v[208:211], v[64:67], v[36:39], v[208:211]
    v_mfma_f32_16x16x32_bf16 v[212:215], v[68:71], v[36:39], v[212:215]
    v_mfma_f32_16x16x32_bf16 v[216:219], v[72:75], v[36:39], v[216:219]
    v_mfma_f32_16x16x32_bf16 v[220:223], v[76:79], v[36:39], v[220:223]
    s_waitcnt lgkmcnt(1)
    v_mfma_f32_16x16x32_bf16 v[224:227], v[80:83], v[40:43], v[224:227]
    v_mfma_f32_16x16x32_bf16 v[228:231], v[84:87], v[40:43], v[228:231]
    v_mfma_f32_16x16x32_bf16 v[232:235], v[88:91], v[40:43], v[232:235]
    s_nop 0
    v_cvt_pk_bf16_f32 v136, v208, v209
    v_cvt_pk_bf16_f32 v137, v210, v211
    v_cvt_pk_bf16_f32 v138, v212, v213
    v_mfma_f32_16x16x32_bf16 v[236:239], v[92:95], v[40:43], v[236:239]
    v_cvt_pk_bf16_f32 v139, v214, v215
    buffer_store_dwordx4 v[136:139], v7, s[28:31], s45 offen offset:0 sc1
    v_cvt_pk_bf16_f32 v140, v216, v217
    s_waitcnt lgkmcnt(0)
    v_mfma_f32_16x16x32_bf16 v[240:243], v[80:83], v[44:47], v[240:243]
    v_cvt_pk_bf16_f32 v141, v218, v219
    v_cvt_pk_bf16_f32 v142, v220, v221
    v_cvt_pk_bf16_f32 v143, v222, v223
    v_mfma_f32_16x16x32_bf16 v[244:247], v[84:87], v[44:47], v[244:247]
    buffer_store_dwordx4 v[140:143], v7, s[28:31], s45 offen offset:1024 sc1
    v_cvt_pk_bf16_f32 v144, v224, v225
    v_cvt_pk_bf16_f32 v145, v226, v227
    v_mfma_f32_16x16x32_bf16 v[248:251], v[88:91], v[44:47], v[248:251]
    v_cvt_pk_bf16_f32 v146, v228, v229
    v_cvt_pk_bf16_f32 v147, v230, v231
    buffer_store_dwordx4 v[144:147], v7, s[28:31], s46 offen offset:0 sc1
    v_mfma_f32_16x16x32_bf16 v[252:255], v[92:95], v[44:47], v[252:255]
    v_cvt_pk_bf16_f32 v148, v232, v233
    v_cvt_pk_bf16_f32 v149, v234, v235
    v_cvt_pk_bf16_f32 v150, v236, v237
    v_mfma_f32_16x16x32_bf16 v[192:195], v[64:67], v[32:35], v[192:195]
    v_cvt_pk_bf16_f32 v151, v238, v239
    buffer_store_dwordx4 v[148:151], v7, s[28:31], s46 offen offset:1024 sc1
    v_cvt_pk_bf16_f32 v152, v240, v241
    v_mfma_f32_16x16x32_bf16 v[196:199], v[68:71], v[32:35], v[196:199]
    v_cvt_pk_bf16_f32 v153, v242, v243
    v_cvt_pk_bf16_f32 v154, v244, v245
    v_cvt_pk_bf16_f32 v155, v246, v247
    v_mfma_f32_16x16x32_bf16 v[200:203], v[72:75], v[32:35], v[200:203]
    buffer_store_dwordx4 v[152:155], v7, s[28:31], s47 offen offset:0 sc1
    v_cvt_pk_bf16_f32 v156, v248, v249
    v_cvt_pk_bf16_f32 v157, v250, v251
    v_mfma_f32_16x16x32_bf16 v[204:207], v[76:79], v[32:35], v[204:207]
    v_cvt_pk_bf16_f32 v158, v252, v253
    v_cvt_pk_bf16_f32 v159, v254, v255
    buffer_store_dwordx4 v[156:159], v7, s[28:31], s47 offen offset:1024 sc1
    s_lshl_b32 s42, s4, 3
    s_add_u32 s42, s42, s40
    s_lshl_b32 s56, s42, 11
    s_lshl_b32 s43, s7, 7
    s_add_u32 s56, s56, s43
    s_add_u32 s56, s56, 0x10000
    v_and_b32 v3, 3, v0
    v_min_u32 v3, 2, v3
    v_add_u32 v3, s4, v3
    v_add_u32 v3, 1, v3
    v_and_b32 v3, 3, v3
    v_lshlrev_b32 v3, 9, v3
    v_mov_b32 v120, v112
    v_mov_b32 v121, v113
    v_mov_b32 v122, v112
    v_mov_b32 v123, v113
    s_lshl_b32 s42, s42, 15
    s_lshl_b32 s43, s7, 11
    s_add_u32 s42, s42, s43
    s_add_u32 s42, s42, 0x400000
    s_add_u32 s43, s4, 1
    s_and_b32 s43, s43, 3
    s_lshl_b32 s43, s43, 13
    s_add_u32 s58, s43, s42
    s_add_u32 s43, s4, 2
    s_and_b32 s43, s43, 3
    s_lshl_b32 s43, s43, 13
    s_add_u32 s59, s43, s42
    s_add_u32 s43, s4, 3
    s_and_b32 s43, s43, 3
    s_lshl_b32 s43, s43, 13
    s_add_u32 s60, s43, s42
    v_lshrrev_b32 v4, 3, v0
    v_lshlrev_b32 v4, 12, v4
    v_and_b32 v5, 7, v0
    v_lshl_add_u32 v4, v5, 4, v4
    s_lshr_b32 s41, s4, 1
    s_xor_b32 s41, s41, s7
    s_xor_b32 s41, s41, 1
    s_lshl_b32 s41, s41, 17
    s_lshl_b32 s40, s5, 19
    s_add_u32 s40, s40, s41
    s_and_b32 s41, s4, 1
    s_lshl_b32 s41, s41, 16
    s_add_u32 s40, s40, s41
    s_lshl_b32 s41, s3, 11
    s_add_u32 s40, s40, s41
    s_mul_i32 s41, s57, 3
    s_xor_b32 s41, s41, s6
    s_lshl_b32 s41, s41, 8
    s_add_u32 s40, s40, s41
    s_lshl_b32 s41, s57, 7
    s_add_u32 s40, s40, s41
    s_add_u32 s41, s40, 0x8000
    s_lshl_b32 s42, s7, 11
    s_add_u32 s42, s42, 32768
    v_and_b32 v1, 15, v0
    v_lshrrev_b32 v2, 5, v0
    v_xor_b32 v2, v2, v5
    v_lshlrev_b32 v2, 4, v2
    v_lshl_add_u32 v1, v1, 7, v2
    v_bfe_u32 v2, v0, 4, 1
    v_lshl_add_u32 v1, v2, 3, v1
    v_add_u32 v1, s42, v1
    v_xor_b32 v13, 32, v1
    v_xor_b32 v14, 64, v1
    v_xor_b32 v15, 96, v1
    v_lshrrev_b32 v2, 3, v0
    v_xor_b32 v5, v5, v2
    v_lshlrev_b32 v5, 4, v5
    v_lshl_add_u32 v2, v2, 7, v5
    v_add_u32 v2, s42, v2
    s_mov_b32 s44, 100000
    s_mov_b64 exec, 0xff
    s_waitcnt vmcnt(4)
    buffer_store_dwordx4 v[120:123], v7, s[28:31], s53 offen sc1
    s_waitcnt vmcnt(3)
    buffer_store_dwordx4 v[120:123], v7, s[28:31], s54 offen sc1
    s_waitcnt vmcnt(2)
    buffer_store_dwordx4 v[120:123], v7, s[28:31], s55 offen sc1
    s_mov_b64 exec, -1
L_xpoll:
    buffer_load_dwordx2 v[8:9], v3, s[28:31], s56 offen sc1
    s_sub_u32 s44, s44, 1
    s_cmp_eq_u32 s44, 0
    s_waitcnt vmcnt(0)
    s_cbranch_scc1 L_xrd
    v_cmp_ne_u64 vcc, v[8:9], v[112:113]
    s_cbranch_vccnz L_xpoll
L_xrd:
    buffer_load_dwordx4 v[64:67], v7, s[28:31], s58 offen offset:0 sc1
    buffer_load_dwordx4 v[68:71], v7, s[28:31], s58 offen offset:1024 sc1
    buffer_load_dwordx4 v[72:75], v7, s[28:31], s59 offen offset:0 sc1
    buffer_load_dwordx4 v[76:79], v7, s[28:31], s59 offen offset:1024 sc1
    buffer_load_dwordx4 v[80:83], v7, s[28:31], s60 offen offset:0 sc1
    buffer_load_dwordx4 v[84:87], v7, s[28:31], s60 offen offset:1024 sc1
    s_waitcnt vmcnt(4)
    v_lshlrev_b32 v5, 16, v64
    v_and_b32 v10, 0xffff0000, v64
    v_add_f32 v192, v192, v5
    v_add_f32 v193, v193, v10
    v_lshlrev_b32 v5, 16, v65
    v_and_b32 v10, 0xffff0000, v65
    v_add_f32 v194, v194, v5
    v_add_f32 v195, v195, v10
    v_lshlrev_b32 v5, 16, v66
    v_and_b32 v10, 0xffff0000, v66
    v_add_f32 v196, v196, v5
    v_add_f32 v197, v197, v10
    v_lshlrev_b32 v5, 16, v67
    v_and_b32 v10, 0xffff0000, v67
    v_add_f32 v198, v198, v5
    v_add_f32 v199, v199, v10
    v_lshlrev_b32 v5, 16, v68
    v_and_b32 v10, 0xffff0000, v68
    v_add_f32 v200, v200, v5
    v_add_f32 v201, v201, v10
    v_lshlrev_b32 v5, 16, v69
    v_and_b32 v10, 0xffff0000, v69
    v_add_f32 v202, v202, v5
    v_add_f32 v203, v203, v10
    v_lshlrev_b32 v5, 16, v70
    v_and_b32 v10, 0xffff0000, v70
    v_add_f32 v204, v204, v5
    v_add_f32 v205, v205, v10
    v_lshlrev_b32 v5, 16, v71
    v_and_b32 v10, 0xffff0000, v71
    v_add_f32 v206, v206, v5
    v_add_f32 v207, v207, v10
    s_waitcnt vmcnt(2)
    v_lshlrev_b32 v5, 16, v72
    v_and_b32 v10, 0xffff0000, v72
    v_add_f32 v192, v192, v5
    v_add_f32 v193, v193, v10
    v_lshlrev_b32 v5, 16, v73
    v_and_b32 v10, 0xffff0000, v73
    v_add_f32 v194, v194, v5
    v_add_f32 v195, v195, v10
    v_lshlrev_b32 v5, 16, v74
    v_and_b32 v10, 0xffff0000, v74
    v_add_f32 v196, v196, v5
    v_add_f32 v197, v197, v10
    v_lshlrev_b32 v5, 16, v75
    v_and_b32 v10, 0xffff0000, v75
    v_add_f32 v198, v198, v5
    v_add_f32 v199, v199, v10
    v_lshlrev_b32 v5, 16, v76
    v_and_b32 v10, 0xffff0000, v76
    v_add_f32 v200, v200, v5
    v_add_f32 v201, v201, v10
    v_lshlrev_b32 v5, 16, v77
    v_and_b32 v10, 0xffff0000, v77
    v_add_f32 v202, v202, v5
    v_add_f32 v203, v203, v10
    v_lshlrev_b32 v5, 16, v78
    v_and_b32 v10, 0xffff0000, v78
    v_add_f32 v204, v204, v5
    v_add_f32 v205, v205, v10
    v_lshlrev_b32 v5, 16, v79
    v_and_b32 v10, 0xffff0000, v79
    v_add_f32 v206, v206, v5
    v_add_f32 v207, v207, v10
    s_waitcnt vmcnt(0)
    v_lshlrev_b32 v5, 16, v80
    v_and_b32 v10, 0xffff0000, v80
    v_add_f32 v192, v192, v5
    v_add_f32 v193, v193, v10
    v_lshlrev_b32 v5, 16, v81
    v_and_b32 v10, 0xffff0000, v81
    v_add_f32 v194, v194, v5
    v_add_f32 v195, v195, v10
    v_lshlrev_b32 v5, 16, v82
    v_and_b32 v10, 0xffff0000, v82
    v_add_f32 v196, v196, v5
    v_add_f32 v197, v197, v10
    v_lshlrev_b32 v5, 16, v83
    v_and_b32 v10, 0xffff0000, v83
    v_add_f32 v198, v198, v5
    v_add_f32 v199, v199, v10
    v_lshlrev_b32 v5, 16, v84
    v_and_b32 v10, 0xffff0000, v84
    v_add_f32 v200, v200, v5
    v_add_f32 v201, v201, v10
    v_lshlrev_b32 v5, 16, v85
    v_and_b32 v10, 0xffff0000, v85
    v_add_f32 v202, v202, v5
    v_add_f32 v203, v203, v10
    v_lshlrev_b32 v5, 16, v86
    v_and_b32 v10, 0xffff0000, v86
    v_add_f32 v204, v204, v5
    v_add_f32 v205, v205, v10
    v_lshlrev_b32 v5, 16, v87
    v_and_b32 v10, 0xffff0000, v87
    v_add_f32 v206, v206, v5
    v_add_f32 v207, v207, v10
    v_cvt_pk_bf16_f32 v16, v192, v193
    v_cvt_pk_bf16_f32 v17, v194, v195
    v_cvt_pk_bf16_f32 v18, v196, v197
    v_cvt_pk_bf16_f32 v19, v198, v199
    v_cvt_pk_bf16_f32 v20, v200, v201
    v_cvt_pk_bf16_f32 v21, v202, v203
    v_cvt_pk_bf16_f32 v22, v204, v205
    v_cvt_pk_bf16_f32 v23, v206, v207
    ds_write_b64 v1, v[16:17]
    ds_write_b64 v13, v[18:19]
    ds_write_b64 v14, v[20:21]
    ds_write_b64 v15, v[22:23]
    ds_read_b128 v[24:27], v2
    ds_read_b128 v[28:31], v2 offset:1024
    s_waitcnt lgkmcnt(1)
    buffer_store_dwordx4 v[24:27], v4, s[32:35], s40 offen sc1
    s_waitcnt lgkmcnt(0)
    buffer_store_dwordx4 v[28:31], v4, s[32:35], s41 offen sc1
    s_or_b32 s40, s4, s6
    s_or_b32 s40, s40, s7
    s_cmp_lg_u32 s40, 0
    s_cbranch_scc1 L_noep
    s_lshl_b32 s40, s38, 7
    buffer_store_dwordx2 v[112:113], v114, s[28:31], s40 offen sc1
L_noep:
    s_endpgm
L_code_end:
.section .rodata,"a"
.p2align 6
.amdhsa_kernel concat_heads__mha_block_cached__mha_block_cached__near_ridge_kernel
  .amdhsa_next_free_vgpr 256
  .amdhsa_next_free_sgpr 102
  .amdhsa_accum_offset 256
  .amdhsa_group_segment_fixed_size 0
  .amdhsa_kernarg_size 104
  .amdhsa_user_sgpr_count 2
  .amdhsa_user_sgpr_kernarg_segment_ptr 1
  .amdhsa_system_sgpr_workgroup_id_x 1
.end_amdhsa_kernel
```
